```python
import torch

def _softmax(x, axis=-1):
    return torch.softmax(x, dim=axis)
def _gelu(x):
    return torch.nn.functional.gelu(x, approximate="tanh")
def _silu(x):
    return torch.nn.functional.silu(x)
def _sigmoid(x):
    return torch.sigmoid(x)
def _layernorm(x, axis=-1, eps=1e-5):
    m = x.mean(dim=axis, keepdim=True)
    v = x.var(dim=axis, keepdim=True, unbiased=False)
    return (x - m) / torch.sqrt(v + eps)
def _scatter_add(tgt, idx, src, axis=0):
    return tgt.clone().index_add_(axis, idx, src)
def _segment_sum(src, seg, n):
    out = torch.zeros((n,) + src.shape[1:], dtype=src.dtype)
    return out.index_add_(0, seg, src)
def _pad(x, pw):
    flat = tuple(v for pair in reversed(pw) for v in pair)
    return torch.nn.functional.pad(x, flat)

kernel_name = 'concat_heads__linear_kernel_hedgehog__mha_block__prompt'

def setup_inputs():

    _w = (lambda a: (lambda t: t.to(torch.bfloat16) if t.is_floating_point() else t)(torch.as_tensor(a)))
    def _A_setup():
        B, S, D, H = 1, 2048, 640, 32
        Dh = D // H
        return {
            "x": _w((lambda *s: torch.randn(*s, dtype=torch.bfloat16) * 0.4)(B, S, D)),
            "wqkv": _w((lambda *s: torch.randn(*s, dtype=torch.bfloat16) * 0.4)(D, 3 * D)),
            "w_phi": _w((lambda *s: torch.randn(*s, dtype=torch.bfloat16) * 0.4)(H, Dh, Dh) * (Dh ** -0.5)),
            "wo": _w((lambda *s: torch.randn(*s, dtype=torch.bfloat16) * 0.05)(D, D)),
        }
    _A_in = _A_setup()

    def _B_setup():
        B, S, D, H = 1, 2048, 640, 32
        return {
            "x": _w((lambda *s: torch.randn(*s, dtype=torch.bfloat16) * 0.2)(B, S, D)),
            "wqkv": _w((lambda *s: torch.randn(*s, dtype=torch.bfloat16) * 0.2)(D, 3 * D)),
            "wo": _w((lambda *s: torch.randn(*s, dtype=torch.bfloat16) * 0.05)(D, D)),
        }
    _B_in = _B_setup()

    return {
        "A_x": _A_in["x"],
        "A_wqkv": _A_in["wqkv"],
        "A_w_phi": _A_in["w_phi"],
        "A_wo": _A_in["wo"],
        "B_x": _B_in["x"],
        "B_wqkv": _B_in["wqkv"],
        "B_wo": _B_in["wo"],
    }

def reference(A_x, A_wqkv, A_w_phi, A_wo, B_x, B_wqkv, B_wo):
    def _A_ref(x, wqkv, w_phi, wo):
        B, S, D = x.shape
        H = 32; Dh = D // H
        qkv = (lambda x, *d: x.permute(*d))((x @ wqkv).reshape(B, S, 3, H, Dh), 2, 0, 3, 1, 4)
        q, k, v = qkv[0], qkv[1], qkv[2]
        pq = torch.einsum("bhsd,hdf->bhsf", q, w_phi)
        pk = torch.einsum("bhsd,hdf->bhsf", k, w_phi)
        phi_q = torch.concatenate([_softmax(pq, axis=-1), _softmax(-pq, axis=-1)], axis=-1)
        phi_k = torch.concatenate([_softmax(pk, axis=-1), _softmax(-pk, axis=-1)], axis=-1)
        kv = torch.einsum("bhsf,bhsd->bhfd", phi_k, v)
        z  = torch.einsum("bhsf->bhf", phi_k)
        num = torch.einsum("bhqf,bhfd->bhqd", phi_q, kv)
        den = torch.einsum("bhqf,bhf->bhq", phi_q, z)[..., None] + 1e-6
        o = num / den
        return (lambda x, *d: x.permute(*d))(o, 0, 2, 1, 3).reshape(B, S, D) @ wo

    def _B_ref(x, wqkv, wo):
        B, S, D = x.shape
        H = 32
        Dh = D // H
        qkv = (lambda x, *d: x.permute(*d))((x @ wqkv).reshape(B, S, 3, H, Dh), 2, 0, 3, 1, 4)
        q, k, v = qkv[0], qkv[1], qkv[2]
        scores = torch.einsum("bhqd,bhkd->bhqk", q, k) * (Dh ** -0.5)
        p = _softmax(scores, axis=-1)
        o = torch.einsum("bhqk,bhkd->bhqd", p, v)
        return (lambda x, *d: x.permute(*d))(o, 0, 2, 1, 3).reshape(B, S, D) @ wo

    a = _A_ref(A_x, A_wqkv, A_w_phi, A_wo)
    b = _B_ref(B_x, B_wqkv, B_wo)
    return torch.concatenate([a, b], axis=-1)
```

```asm
; @launch kernel=qkv_kernel grid=(256,1,1) block=(512,1,1) lds=81920
; @launch kernel=attn_kernel grid=(512,1,1) block=(512,1,1) lds=81920
.amdgcn_target "amdgcn-amd-amdhsa--gfx950"
.text
.globl qkv_kernel
.p2align 8
.type qkv_kernel,@function
qkv_kernel:
    s_cmp_ge_u32 s2, 256
    s_cbranch_scc1 L_done_1001
    s_load_dwordx2 s[8:9], s[0:1], 32
    s_load_dwordx2 s[12:13], s[0:1], 40
    s_load_dwordx2 s[16:17], s[0:1], 72
    v_lshrrev_b32 v52, 6, v0
    v_and_b32 v0, 63, v0
    v_readfirstlane_b32 s20, v52
    s_nop 3
    s_lshr_b32 s39, s20, 2
    s_and_b32 s20, s20, 3
    s_and_b32 s25, s2, 7
    s_lshr_b32 s26, s2, 3
    s_lshr_b32 s27, s25, 1
    s_lshl_b32 s27, s27, 2
    s_and_b32 s28, s25, 1
    s_lshr_b32 s29, s26, 3
    s_and_b32 s30, s26, 7
    s_mul_i32 s31, s26, 37
    s_lshr_b32 s31, s31, 8
    s_mul_i32 s32, s31, 7
    s_sub_u32 s32, s26, s32
    s_add_u32 s32, s32, 8
    s_cmp_eq_u32 s28, 0
    s_cselect_b32 s40, s29, s31
    s_cselect_b32 s41, s30, s32
    s_add_u32 s40, s40, s27
    s_mul_i32 s21, s40, 163840
    s_lshl_b32 s22, s41, 8
    s_waitcnt lgkmcnt(0)
    s_mov_b32 s10, 2621440
    s_mov_b32 s11, 0x00020000
    s_mov_b32 s14, 2457600
    s_mov_b32 s15, 0x00020000
    s_mov_b32 s18, 33554432
    s_mov_b32 s19, 0x00020000
    s_cmp_eq_u32 s28, 0
    s_cbranch_scc1 L_bq_go_1002
    s_cmp_lt_u32 s26, 28
    s_cbranch_scc1 L_bq_go_1002
    s_cmp_lg_u32 s2, 225
    s_cbranch_scc1 L_bq_z0_1003
    s_mov_b32 s25, 15204352
    s_lshl_b32 s27, s39, 2
    s_add_u32 s27, s27, s20
    s_lshl_b32 s27, s27, 6
    v_add_u32 v52, s27, v0
    v_lshlrev_b32 v53, 4, v52
    v_mov_b32 v56, 0
    v_mov_b32 v57, 0
    v_mov_b32 v58, 0
    v_mov_b32 v59, 0
    v_cmp_gt_u32 vcc, 512, v52
    s_nop 1
    s_and_b64 exec, exec, vcc
    s_cbranch_execz L_bq_zskip_1004
    buffer_store_dwordx4 v[56:59], v53, s[16:19], s25 offen sc1
L_bq_zskip_1004:
L_bq_z0_1003:
    s_endpgm
L_bq_go_1002:
    s_and_b32 s33, s40, 3
    s_mul_i32 s33, s33, 10
    s_and_b32 s34, s41, 7
    s_mul_i32 s34, s34, 5
    s_add_u32 s33, s33, s34
    s_lshr_b32 s33, s33, 1
    s_cmp_ge_u32 s33, 20
    s_cselect_b32 s34, 20, 0
    s_sub_u32 s59, s33, s34
    s_mov_b32 s67, s22
    s_mov_b32 s64, s26
    s_mov_b32 s65, s28
    s_mov_b32 s66, s27
    s_cmp_eq_u32 s39, 0
    s_cbranch_scc1 L_compute_1006
    v_lshrrev_b32 v3, 2, v0
    v_lshrrev_b32 v4, 4, v0
    v_and_b32 v5, 3, v0
    v_xor_b32 v5, v5, v4
    v_lshlrev_b32 v5, 4, v5
    s_lshl_b32 s25, s20, 4
    v_add_u32 v3, s25, v3
    v_mul_u32_u24 v1, 1280, v3
    v_add_u32 v1, v1, v5
    v_lshrrev_b32 v3, 4, v0
    v_and_b32 v4, 15, v0
    v_lshlrev_b32 v5, 2, v3
    v_xor_b32 v4, v4, v5
    v_lshlrev_b32 v4, 4, v4
    s_lshl_b32 s25, s20, 3
    v_add_u32 v3, s25, v3
    v_mul_u32_u24 v2, 3840, v3
    v_add_u32 v2, v2, v4
    v_add_u32 v8, 81920, v1
    v_add_u32 v9, 14336, v2
    s_mov_b32 s68, 122880
    s_mov_b32 s69, -2334720
    s_mov_b32 s58, s59
    s_mul_i32 s29, s59, 64
    s_add_u32 s21, s21, s29
    s_mul_i32 s29, s59, 122880
    s_add_u32 s22, s22, s29
    s_lshl_b32 s27, s20, 10
    s_lshl_b32 s28, s20, 11
    s_add_u32 m0, s27, 0
    s_add_u32 s58, s58, 1
    buffer_load_dwordx4 v1, s[8:11], s21 offen lds
    s_add_u32 m0, s27, 4096
    s_cmp_eq_u32 s58, 20
    buffer_load_dwordx4 v8, s[8:11], s21 offen lds
    s_cselect_b32 s29, -1216, 64
    s_add_u32 m0, s28, 40960
    s_add_u32 s21, s21, s29
    buffer_load_dwordx4 v2, s[12:15], s22 offen lds
    buffer_load_dwordx4 v9, s[12:15], s22 offen offset:1024 lds
    s_cmp_eq_u32 s58, 20
    s_cselect_b32 s29, s69, s68
    s_add_u32 s22, s22, s29
    s_add_u32 m0, s27, 8192
    s_add_u32 s58, s58, 1
    buffer_load_dwordx4 v1, s[8:11], s21 offen lds
    s_add_u32 m0, s27, 12288
    s_cmp_eq_u32 s58, 20
    buffer_load_dwordx4 v8, s[8:11], s21 offen lds
    s_cselect_b32 s29, -1216, 64
    s_add_u32 m0, s28, 49152
    s_add_u32 s21, s21, s29
    buffer_load_dwordx4 v2, s[12:15], s22 offen lds
    buffer_load_dwordx4 v9, s[12:15], s22 offen offset:1024 lds
    s_cmp_eq_u32 s58, 20
    s_cselect_b32 s29, s69, s68
    s_add_u32 s22, s22, s29
    s_add_u32 m0, s27, 16384
    s_add_u32 s58, s58, 1
    buffer_load_dwordx4 v1, s[8:11], s21 offen lds
    s_add_u32 m0, s27, 20480
    s_cmp_eq_u32 s58, 20
    buffer_load_dwordx4 v8, s[8:11], s21 offen lds
    s_cselect_b32 s29, -1216, 64
    s_add_u32 m0, s28, 57344
    s_add_u32 s21, s21, s29
    buffer_load_dwordx4 v2, s[12:15], s22 offen lds
    buffer_load_dwordx4 v9, s[12:15], s22 offen offset:1024 lds
    s_cmp_eq_u32 s58, 20
    s_cselect_b32 s29, s69, s68
    s_add_u32 s22, s22, s29
    s_lshl_b32 s29, s20, 6
    v_add_u32 v3, s29, v0
    v_lshrrev_b32 v4, 1, v3
    v_and_b32 v5, 1, v3
    v_lshlrev_b32 v5, 7, v5
    s_lshl_b32 s29, s58, 5
    v_add_u32 v4, s29, v4
    v_subrev_u32 v6, 640, v4
    v_cmp_le_u32 vcc, 640, v4
    s_nop 1
    v_cndmask_b32 v4, v4, v6, vcc
    v_mul_u32_u24 v4, 3840, v4
    v_add_u32 v4, v4, v5
    v_cmp_gt_u32 vcc, 128, v3
    v_mov_b32 v5, 0x7ffffff0
    s_nop 0
    v_cndmask_b32 v4, v5, v4, vcc
    buffer_load_dword v7, v4, s[12:15], s67 offen
    s_waitcnt vmcnt(9)
    s_barrier
    s_add_u32 m0, s27, 24576
    s_add_u32 s58, s58, 1
    buffer_load_dwordx4 v1, s[8:11], s21 offen lds
    s_add_u32 m0, s27, 28672
    s_cmp_eq_u32 s58, 20
    buffer_load_dwordx4 v8, s[8:11], s21 offen lds
    s_cselect_b32 s29, -1216, 64
    s_add_u32 m0, s28, 65536
    s_add_u32 s21, s21, s29
    buffer_load_dwordx4 v2, s[12:15], s22 offen lds
    buffer_load_dwordx4 v9, s[12:15], s22 offen offset:1024 lds
    s_cmp_eq_u32 s58, 20
    s_cselect_b32 s29, s69, s68
    s_add_u32 s22, s22, s29
    s_waitcnt vmcnt(9)
    s_barrier
    s_add_u32 m0, s27, 32768
    s_add_u32 s58, s58, 1
    buffer_load_dwordx4 v1, s[8:11], s21 offen lds
    s_add_u32 m0, s27, 36864
    s_cmp_eq_u32 s58, 20
    buffer_load_dwordx4 v8, s[8:11], s21 offen lds
    s_cselect_b32 s29, -1216, 64
    s_add_u32 m0, s28, 73728
    s_add_u32 s21, s21, s29
    buffer_load_dwordx4 v2, s[12:15], s22 offen lds
    buffer_load_dwordx4 v9, s[12:15], s22 offen offset:1024 lds
    s_cmp_eq_u32 s58, 20
    s_cselect_b32 s29, s69, s68
    s_add_u32 s22, s22, s29
    s_waitcnt vmcnt(9)
    s_barrier
    s_add_u32 m0, s27, 0
    s_add_u32 s58, s58, 1
    buffer_load_dwordx4 v1, s[8:11], s21 offen lds
    s_add_u32 m0, s27, 4096
    s_cmp_eq_u32 s58, 20
    buffer_load_dwordx4 v8, s[8:11], s21 offen lds
    s_cselect_b32 s29, -1216, 64
    s_add_u32 m0, s28, 40960
    s_add_u32 s21, s21, s29
    buffer_load_dwordx4 v2, s[12:15], s22 offen lds
    buffer_load_dwordx4 v9, s[12:15], s22 offen offset:1024 lds
    s_cmp_eq_u32 s58, 20
    s_cselect_b32 s29, s69, s68
    s_add_u32 s22, s22, s29
    s_waitcnt vmcnt(8)
    s_barrier
    s_add_u32 m0, s27, 8192
    s_add_u32 s58, s58, 1
    buffer_load_dwordx4 v1, s[8:11], s21 offen lds
    s_add_u32 m0, s27, 12288
    s_cmp_eq_u32 s58, 20
    buffer_load_dwordx4 v8, s[8:11], s21 offen lds
    s_cselect_b32 s29, -1216, 64
    s_add_u32 m0, s28, 49152
    s_add_u32 s21, s21, s29
    buffer_load_dwordx4 v2, s[12:15], s22 offen lds
    buffer_load_dwordx4 v9, s[12:15], s22 offen offset:1024 lds
    s_cmp_eq_u32 s58, 20
    s_cselect_b32 s29, s69, s68
    s_add_u32 s22, s22, s29
    s_waitcnt vmcnt(8)
    s_barrier
    s_add_u32 m0, s27, 16384
    s_add_u32 s58, s58, 1
    buffer_load_dwordx4 v1, s[8:11], s21 offen lds
    s_add_u32 m0, s27, 20480
    s_cmp_eq_u32 s58, 20
    buffer_load_dwordx4 v8, s[8:11], s21 offen lds
    s_cselect_b32 s29, -1216, 64
    s_add_u32 m0, s28, 57344
    s_add_u32 s21, s21, s29
    buffer_load_dwordx4 v2, s[12:15], s22 offen lds
    buffer_load_dwordx4 v9, s[12:15], s22 offen offset:1024 lds
    s_cmp_eq_u32 s58, 20
    s_cselect_b32 s29, s69, s68
    s_add_u32 s22, s22, s29
    s_waitcnt vmcnt(8)
    s_barrier
    s_add_u32 m0, s27, 24576
    s_add_u32 s58, s58, 1
    buffer_load_dwordx4 v1, s[8:11], s21 offen lds
    s_add_u32 m0, s27, 28672
    s_cmp_eq_u32 s58, 20
    buffer_load_dwordx4 v8, s[8:11], s21 offen lds
    s_cselect_b32 s29, -1216, 64
    s_add_u32 m0, s28, 65536
    s_add_u32 s21, s21, s29
    buffer_load_dwordx4 v2, s[12:15], s22 offen lds
    buffer_load_dwordx4 v9, s[12:15], s22 offen offset:1024 lds
    s_cmp_eq_u32 s58, 20
    s_cselect_b32 s29, s69, s68
    s_add_u32 s22, s22, s29
    s_waitcnt vmcnt(8)
    s_barrier
    s_add_u32 m0, s27, 32768
    s_add_u32 s58, s58, 1
    buffer_load_dwordx4 v1, s[8:11], s21 offen lds
    s_add_u32 m0, s27, 36864
    s_cmp_eq_u32 s58, 20
    buffer_load_dwordx4 v8, s[8:11], s21 offen lds
    s_cselect_b32 s29, -1216, 64
    s_add_u32 m0, s28, 73728
    s_add_u32 s21, s21, s29
    buffer_load_dwordx4 v2, s[12:15], s22 offen lds
    buffer_load_dwordx4 v9, s[12:15], s22 offen offset:1024 lds
    s_cmp_eq_u32 s58, 20
    s_cselect_b32 s29, s69, s68
    s_add_u32 s22, s22, s29
    s_waitcnt vmcnt(8)
    s_barrier
    s_add_u32 m0, s27, 0
    s_add_u32 s58, s58, 1
    buffer_load_dwordx4 v1, s[8:11], s21 offen lds
    s_add_u32 m0, s27, 4096
    s_cmp_eq_u32 s58, 20
    buffer_load_dwordx4 v8, s[8:11], s21 offen lds
    s_cselect_b32 s29, -1216, 64
    s_add_u32 m0, s28, 40960
    s_add_u32 s21, s21, s29
    buffer_load_dwordx4 v2, s[12:15], s22 offen lds
    buffer_load_dwordx4 v9, s[12:15], s22 offen offset:1024 lds
    s_cmp_eq_u32 s58, 20
    s_cselect_b32 s29, s69, s68
    s_add_u32 s22, s22, s29
    s_waitcnt vmcnt(8)
    s_barrier
    s_add_u32 m0, s27, 8192
    s_add_u32 s58, s58, 1
    buffer_load_dwordx4 v1, s[8:11], s21 offen lds
    s_add_u32 m0, s27, 12288
    s_cmp_eq_u32 s58, 20
    buffer_load_dwordx4 v8, s[8:11], s21 offen lds
    s_cselect_b32 s29, -1216, 64
    s_add_u32 m0, s28, 49152
    s_add_u32 s21, s21, s29
    buffer_load_dwordx4 v2, s[12:15], s22 offen lds
    buffer_load_dwordx4 v9, s[12:15], s22 offen offset:1024 lds
    s_cmp_eq_u32 s58, 20
    s_cselect_b32 s29, s69, s68
    s_add_u32 s22, s22, s29
    s_waitcnt vmcnt(8)
    s_barrier
    s_add_u32 m0, s27, 16384
    s_add_u32 s58, s58, 1
    buffer_load_dwordx4 v1, s[8:11], s21 offen lds
    s_add_u32 m0, s27, 20480
    s_cmp_eq_u32 s58, 20
    buffer_load_dwordx4 v8, s[8:11], s21 offen lds
    s_cselect_b32 s29, -1216, 64
    s_add_u32 m0, s28, 57344
    s_add_u32 s21, s21, s29
    buffer_load_dwordx4 v2, s[12:15], s22 offen lds
    buffer_load_dwordx4 v9, s[12:15], s22 offen offset:1024 lds
    s_cmp_eq_u32 s58, 20
    s_cselect_b32 s29, s69, s68
    s_add_u32 s22, s22, s29
    s_waitcnt vmcnt(8)
    s_barrier
    s_add_u32 m0, s27, 24576
    s_add_u32 s58, s58, 1
    buffer_load_dwordx4 v1, s[8:11], s21 offen lds
    s_add_u32 m0, s27, 28672
    s_cmp_eq_u32 s58, 20
    buffer_load_dwordx4 v8, s[8:11], s21 offen lds
    s_cselect_b32 s29, -1216, 64
    s_add_u32 m0, s28, 65536
    s_add_u32 s21, s21, s29
    buffer_load_dwordx4 v2, s[12:15], s22 offen lds
    buffer_load_dwordx4 v9, s[12:15], s22 offen offset:1024 lds
    s_cmp_eq_u32 s58, 20
    s_cselect_b32 s29, s69, s68
    s_add_u32 s22, s22, s29
    s_waitcnt vmcnt(8)
    s_barrier
    s_add_u32 m0, s27, 32768
    s_add_u32 s58, s58, 1
    buffer_load_dwordx4 v1, s[8:11], s21 offen lds
    s_add_u32 m0, s27, 36864
    s_cmp_eq_u32 s58, 20
    buffer_load_dwordx4 v8, s[8:11], s21 offen lds
    s_cselect_b32 s29, -1216, 64
    s_add_u32 m0, s28, 73728
    s_add_u32 s21, s21, s29
    buffer_load_dwordx4 v2, s[12:15], s22 offen lds
    buffer_load_dwordx4 v9, s[12:15], s22 offen offset:1024 lds
    s_cmp_eq_u32 s58, 20
    s_cselect_b32 s29, s69, s68
    s_add_u32 s22, s22, s29
    s_waitcnt vmcnt(8)
    s_barrier
    s_add_u32 m0, s27, 0
    s_add_u32 s58, s58, 1
    buffer_load_dwordx4 v1, s[8:11], s21 offen lds
    s_add_u32 m0, s27, 4096
    s_cmp_eq_u32 s58, 20
    buffer_load_dwordx4 v8, s[8:11], s21 offen lds
    s_cselect_b32 s29, -1216, 64
    s_add_u32 m0, s28, 40960
    s_add_u32 s21, s21, s29
    buffer_load_dwordx4 v2, s[12:15], s22 offen lds
    buffer_load_dwordx4 v9, s[12:15], s22 offen offset:1024 lds
    s_cmp_eq_u32 s58, 20
    s_cselect_b32 s29, s69, s68
    s_add_u32 s22, s22, s29
    s_waitcnt vmcnt(8)
    s_barrier
    s_add_u32 m0, s27, 8192
    s_add_u32 s58, s58, 1
    buffer_load_dwordx4 v1, s[8:11], s21 offen lds
    s_add_u32 m0, s27, 12288
    s_cmp_eq_u32 s58, 20
    buffer_load_dwordx4 v8, s[8:11], s21 offen lds
    s_cselect_b32 s29, -1216, 64
    s_add_u32 m0, s28, 49152
    s_add_u32 s21, s21, s29
    buffer_load_dwordx4 v2, s[12:15], s22 offen lds
    buffer_load_dwordx4 v9, s[12:15], s22 offen offset:1024 lds
    s_cmp_eq_u32 s58, 20
    s_cselect_b32 s29, s69, s68
    s_add_u32 s22, s22, s29
    s_waitcnt vmcnt(8)
    s_barrier
    s_add_u32 m0, s27, 16384
    s_add_u32 s58, s58, 1
    buffer_load_dwordx4 v1, s[8:11], s21 offen lds
    s_add_u32 m0, s27, 20480
    s_cmp_eq_u32 s58, 20
    buffer_load_dwordx4 v8, s[8:11], s21 offen lds
    s_cselect_b32 s29, -1216, 64
    s_add_u32 m0, s28, 57344
    s_add_u32 s21, s21, s29
    buffer_load_dwordx4 v2, s[12:15], s22 offen lds
    buffer_load_dwordx4 v9, s[12:15], s22 offen offset:1024 lds
    s_cmp_eq_u32 s58, 20
    s_cselect_b32 s29, s69, s68
    s_add_u32 s22, s22, s29
    s_waitcnt vmcnt(8)
    s_barrier
    s_add_u32 m0, s27, 24576
    s_add_u32 s58, s58, 1
    buffer_load_dwordx4 v1, s[8:11], s21 offen lds
    s_add_u32 m0, s27, 28672
    s_cmp_eq_u32 s58, 20
    buffer_load_dwordx4 v8, s[8:11], s21 offen lds
    s_cselect_b32 s29, -1216, 64
    s_add_u32 m0, s28, 65536
    s_add_u32 s21, s21, s29
    buffer_load_dwordx4 v2, s[12:15], s22 offen lds
    buffer_load_dwordx4 v9, s[12:15], s22 offen offset:1024 lds
    s_cmp_eq_u32 s58, 20
    s_cselect_b32 s29, s69, s68
    s_add_u32 s22, s22, s29
    s_waitcnt vmcnt(8)
    s_barrier
    s_add_u32 m0, s27, 32768
    s_add_u32 s58, s58, 1
    buffer_load_dwordx4 v1, s[8:11], s21 offen lds
    s_add_u32 m0, s27, 36864
    s_cmp_eq_u32 s58, 20
    buffer_load_dwordx4 v8, s[8:11], s21 offen lds
    s_cselect_b32 s29, -1216, 64
    s_add_u32 m0, s28, 73728
    s_add_u32 s21, s21, s29
    buffer_load_dwordx4 v2, s[12:15], s22 offen lds
    buffer_load_dwordx4 v9, s[12:15], s22 offen offset:1024 lds
    s_cmp_eq_u32 s58, 20
    s_cselect_b32 s29, s69, s68
    s_add_u32 s22, s22, s29
    s_waitcnt vmcnt(8)
    s_barrier
    s_waitcnt vmcnt(4)
    s_barrier
    s_waitcnt vmcnt(0)
    s_barrier
    s_endpgm
L_compute_1006:
    v_and_b32 v52, 31, v0
    s_lshl_b32 s25, s20, 5
    v_add_u32 v52, s25, v52
    v_bfe_u32 v53, v52, 2, 2
    v_lshrrev_b32 v54, 5, v0
    v_xor_b32 v53, v53, v54
    v_lshlrev_b32 v53, 4, v53
    v_lshlrev_b32 v52, 6, v52
    v_add_u32 v1, v52, v53
    v_xor_b32 v2, 32, v1
    v_bfe_u32 v52, v0, 2, 2
    v_lshrrev_b32 v53, 5, v0
    v_lshlrev_b32 v53, 3, v53
    v_add_u32 v53, v53, v52
    v_mul_u32_u24 v53, 256, v53
    v_bfe_u32 v54, v0, 4, 1
    v_lshlrev_b32 v54, 5, v54
    v_add_u32 v53, v53, v54
    v_and_b32 v54, 3, v0
    v_lshlrev_b32 v54, 3, v54
    v_add_u32 v53, v53, v54
    v_add_u32 v53, 40960, v53
    v_xor_b32 v54, 0, v52
    v_lshlrev_b32 v54, 6, v54
    v_add_u32 v3, v53, v54
    v_xor_b32 v54, 1, v52
    v_lshlrev_b32 v54, 6, v54
    v_add_u32 v4, v53, v54
    v_xor_b32 v54, 2, v52
    v_lshlrev_b32 v54, 6, v54
    v_add_u32 v5, v53, v54
    v_xor_b32 v54, 3, v52
    v_lshlrev_b32 v54, 6, v54
    v_add_u32 v6, v53, v54
    s_cmp_ge_u32 s41, 10
    s_cbranch_scc1 L_bq_v_1007
    v_mov_b32 v64, 0
    v_mov_b32 v65, 0
    v_mov_b32 v66, 0
    v_mov_b32 v67, 0
    v_mov_b32 v68, 0
    v_mov_b32 v69, 0
    v_mov_b32 v70, 0
    v_mov_b32 v71, 0
    v_mov_b32 v72, 0
    v_mov_b32 v73, 0
    v_mov_b32 v74, 0
    v_mov_b32 v75, 0
    v_mov_b32 v76, 0
    v_mov_b32 v77, 0
    v_mov_b32 v78, 0
    v_mov_b32 v79, 0
    v_mov_b32 v80, 0
    v_mov_b32 v81, 0
    v_mov_b32 v82, 0
    v_mov_b32 v83, 0
    v_mov_b32 v84, 0
    v_mov_b32 v85, 0
    v_mov_b32 v86, 0
    v_mov_b32 v87, 0
    v_mov_b32 v88, 0
    v_mov_b32 v89, 0
    v_mov_b32 v90, 0
    v_mov_b32 v91, 0
    v_mov_b32 v92, 0
    v_mov_b32 v93, 0
    v_mov_b32 v94, 0
    v_mov_b32 v95, 0
    v_mov_b32 v96, 0
    v_mov_b32 v97, 0
    v_mov_b32 v98, 0
    v_mov_b32 v99, 0
    v_mov_b32 v100, 0
    v_mov_b32 v101, 0
    v_mov_b32 v102, 0
    v_mov_b32 v103, 0
    v_mov_b32 v104, 0
    v_mov_b32 v105, 0
    v_mov_b32 v106, 0
    v_mov_b32 v107, 0
    v_mov_b32 v108, 0
    v_mov_b32 v109, 0
    v_mov_b32 v110, 0
    v_mov_b32 v111, 0
    v_mov_b32 v112, 0
    v_mov_b32 v113, 0
    v_mov_b32 v114, 0
    v_mov_b32 v115, 0
    v_mov_b32 v116, 0
    v_mov_b32 v117, 0
    v_mov_b32 v118, 0
    v_mov_b32 v119, 0
    v_mov_b32 v120, 0
    v_mov_b32 v121, 0
    v_mov_b32 v122, 0
    v_mov_b32 v123, 0
    v_mov_b32 v124, 0
    v_mov_b32 v125, 0
    v_mov_b32 v126, 0
    v_mov_b32 v127, 0
    v_mov_b32 v12, 0
    v_mov_b32 v13, 0
    v_mov_b32 v14, 0
    v_mov_b32 v15, 0
    v_mov_b32 v32, 0
    v_mov_b32 v33, 0
    v_mov_b32 v34, 0
    v_mov_b32 v35, 0
    v_mov_b32 v36, 0
    v_mov_b32 v37, 0
    v_mov_b32 v38, 0
    v_mov_b32 v39, 0
    v_mov_b32 v40, 0
    v_mov_b32 v41, 0
    v_mov_b32 v42, 0
    v_mov_b32 v43, 0
    v_mov_b32 v44, 0
    v_mov_b32 v45, 0
    v_mov_b32 v46, 0
    v_mov_b32 v47, 0
    s_mov_b32 s24, 0
L_gc_loop_1008:
    s_barrier
    s_waitcnt lgkmcnt(6)
    v_mfma_f32_32x32x16_bf16 v[64:79], v[32:35], v[12:15], v[64:79]
    ds_read_b128 v[8:11], v1 offset:0
    ds_read_b64_tr_b16 v[16:17], v3 offset:0
    ds_read_b64_tr_b16 v[18:19], v3 offset:1024
    s_waitcnt lgkmcnt(7)
    v_mfma_f32_32x32x16_bf16 v[80:95], v[36:39], v[12:15], v[80:95]
    ds_read_b64_tr_b16 v[20:21], v4 offset:0
    ds_read_b64_tr_b16 v[22:23], v4 offset:1024
    s_waitcnt lgkmcnt(7)
    v_mfma_f32_32x32x16_bf16 v[96:111], v[40:43], v[12:15], v[96:111]
    ds_read_b64_tr_b16 v[24:25], v5 offset:0
    ds_read_b64_tr_b16 v[26:27], v5 offset:1024
    s_waitcnt lgkmcnt(7)
    v_mfma_f32_32x32x16_bf16 v[112:127], v[44:47], v[12:15], v[112:127]
    ds_read_b64_tr_b16 v[28:29], v6 offset:0
    ds_read_b64_tr_b16 v[30:31], v6 offset:1024
    s_waitcnt lgkmcnt(6)
    v_mfma_f32_32x32x16_bf16 v[64:79], v[16:19], v[8:11], v[64:79]
    ds_read_b128 v[12:15], v2 offset:0
    ds_read_b64_tr_b16 v[32:33], v3 offset:4096
    ds_read_b64_tr_b16 v[34:35], v3 offset:5120
    s_waitcnt lgkmcnt(7)
    v_mfma_f32_32x32x16_bf16 v[80:95], v[20:23], v[8:11], v[80:95]
    ds_read_b64_tr_b16 v[36:37], v4 offset:4096
    ds_read_b64_tr_b16 v[38:39], v4 offset:5120
    s_waitcnt lgkmcnt(7)
    v_mfma_f32_32x32x16_bf16 v[96:111], v[24:27], v[8:11], v[96:111]
    ds_read_b64_tr_b16 v[40:41], v5 offset:4096
    ds_read_b64_tr_b16 v[42:43], v5 offset:5120
    s_waitcnt lgkmcnt(7)
    v_mfma_f32_32x32x16_bf16 v[112:127], v[28:31], v[8:11], v[112:127]
    ds_read_b64_tr_b16 v[44:45], v6 offset:4096
    ds_read_b64_tr_b16 v[46:47], v6 offset:5120
    s_barrier
    s_waitcnt lgkmcnt(6)
    v_mfma_f32_32x32x16_bf16 v[64:79], v[32:35], v[12:15], v[64:79]
    ds_read_b128 v[8:11], v1 offset:8192
    ds_read_b64_tr_b16 v[16:17], v3 offset:8192
    ds_read_b64_tr_b16 v[18:19], v3 offset:9216
    s_waitcnt lgkmcnt(7)
    v_mfma_f32_32x32x16_bf16 v[80:95], v[36:39], v[12:15], v[80:95]
    ds_read_b64_tr_b16 v[20:21], v4 offset:8192
    ds_read_b64_tr_b16 v[22:23], v4 offset:9216
    s_waitcnt lgkmcnt(7)
    v_mfma_f32_32x32x16_bf16 v[96:111], v[40:43], v[12:15], v[96:111]
    ds_read_b64_tr_b16 v[24:25], v5 offset:8192
    ds_read_b64_tr_b16 v[26:27], v5 offset:9216
    s_waitcnt lgkmcnt(7)
    v_mfma_f32_32x32x16_bf16 v[112:127], v[44:47], v[12:15], v[112:127]
    ds_read_b64_tr_b16 v[28:29], v6 offset:8192
    ds_read_b64_tr_b16 v[30:31], v6 offset:9216
    s_waitcnt lgkmcnt(6)
    v_mfma_f32_32x32x16_bf16 v[64:79], v[16:19], v[8:11], v[64:79]
    ds_read_b128 v[12:15], v2 offset:8192
    ds_read_b64_tr_b16 v[32:33], v3 offset:12288
    ds_read_b64_tr_b16 v[34:35], v3 offset:13312
    s_waitcnt lgkmcnt(7)
    v_mfma_f32_32x32x16_bf16 v[80:95], v[20:23], v[8:11], v[80:95]
    ds_read_b64_tr_b16 v[36:37], v4 offset:12288
    ds_read_b64_tr_b16 v[38:39], v4 offset:13312
    s_waitcnt lgkmcnt(7)
    v_mfma_f32_32x32x16_bf16 v[96:111], v[24:27], v[8:11], v[96:111]
    ds_read_b64_tr_b16 v[40:41], v5 offset:12288
    ds_read_b64_tr_b16 v[42:43], v5 offset:13312
    s_waitcnt lgkmcnt(7)
    v_mfma_f32_32x32x16_bf16 v[112:127], v[28:31], v[8:11], v[112:127]
    ds_read_b64_tr_b16 v[44:45], v6 offset:12288
    ds_read_b64_tr_b16 v[46:47], v6 offset:13312
    s_barrier
    s_waitcnt lgkmcnt(6)
    v_mfma_f32_32x32x16_bf16 v[64:79], v[32:35], v[12:15], v[64:79]
    ds_read_b128 v[8:11], v1 offset:16384
    ds_read_b64_tr_b16 v[16:17], v3 offset:16384
    ds_read_b64_tr_b16 v[18:19], v3 offset:17408
    s_waitcnt lgkmcnt(7)
    v_mfma_f32_32x32x16_bf16 v[80:95], v[36:39], v[12:15], v[80:95]
    ds_read_b64_tr_b16 v[20:21], v4 offset:16384
    ds_read_b64_tr_b16 v[22:23], v4 offset:17408
    s_waitcnt lgkmcnt(7)
    v_mfma_f32_32x32x16_bf16 v[96:111], v[40:43], v[12:15], v[96:111]
    ds_read_b64_tr_b16 v[24:25], v5 offset:16384
    ds_read_b64_tr_b16 v[26:27], v5 offset:17408
    s_waitcnt lgkmcnt(7)
    v_mfma_f32_32x32x16_bf16 v[112:127], v[44:47], v[12:15], v[112:127]
    ds_read_b64_tr_b16 v[28:29], v6 offset:16384
    ds_read_b64_tr_b16 v[30:31], v6 offset:17408
    s_waitcnt lgkmcnt(6)
    v_mfma_f32_32x32x16_bf16 v[64:79], v[16:19], v[8:11], v[64:79]
    ds_read_b128 v[12:15], v2 offset:16384
    ds_read_b64_tr_b16 v[32:33], v3 offset:20480
    ds_read_b64_tr_b16 v[34:35], v3 offset:21504
    s_waitcnt lgkmcnt(7)
    v_mfma_f32_32x32x16_bf16 v[80:95], v[20:23], v[8:11], v[80:95]
    ds_read_b64_tr_b16 v[36:37], v4 offset:20480
    ds_read_b64_tr_b16 v[38:39], v4 offset:21504
    s_waitcnt lgkmcnt(7)
    v_mfma_f32_32x32x16_bf16 v[96:111], v[24:27], v[8:11], v[96:111]
    ds_read_b64_tr_b16 v[40:41], v5 offset:20480
    ds_read_b64_tr_b16 v[42:43], v5 offset:21504
    s_waitcnt lgkmcnt(7)
    v_mfma_f32_32x32x16_bf16 v[112:127], v[28:31], v[8:11], v[112:127]
    ds_read_b64_tr_b16 v[44:45], v6 offset:20480
    ds_read_b64_tr_b16 v[46:47], v6 offset:21504
    s_barrier
    s_waitcnt lgkmcnt(6)
    v_mfma_f32_32x32x16_bf16 v[64:79], v[32:35], v[12:15], v[64:79]
    ds_read_b128 v[8:11], v1 offset:24576
    ds_read_b64_tr_b16 v[16:17], v3 offset:24576
    ds_read_b64_tr_b16 v[18:19], v3 offset:25600
    s_waitcnt lgkmcnt(7)
    v_mfma_f32_32x32x16_bf16 v[80:95], v[36:39], v[12:15], v[80:95]
    ds_read_b64_tr_b16 v[20:21], v4 offset:24576
    ds_read_b64_tr_b16 v[22:23], v4 offset:25600
    s_waitcnt lgkmcnt(7)
    v_mfma_f32_32x32x16_bf16 v[96:111], v[40:43], v[12:15], v[96:111]
    ds_read_b64_tr_b16 v[24:25], v5 offset:24576
    ds_read_b64_tr_b16 v[26:27], v5 offset:25600
    s_waitcnt lgkmcnt(7)
    v_mfma_f32_32x32x16_bf16 v[112:127], v[44:47], v[12:15], v[112:127]
    ds_read_b64_tr_b16 v[28:29], v6 offset:24576
    ds_read_b64_tr_b16 v[30:31], v6 offset:25600
    s_waitcnt lgkmcnt(6)
    v_mfma_f32_32x32x16_bf16 v[64:79], v[16:19], v[8:11], v[64:79]
    ds_read_b128 v[12:15], v2 offset:24576
    ds_read_b64_tr_b16 v[32:33], v3 offset:28672
    ds_read_b64_tr_b16 v[34:35], v3 offset:29696
    s_waitcnt lgkmcnt(7)
    v_mfma_f32_32x32x16_bf16 v[80:95], v[20:23], v[8:11], v[80:95]
    ds_read_b64_tr_b16 v[36:37], v4 offset:28672
    ds_read_b64_tr_b16 v[38:39], v4 offset:29696
    s_waitcnt lgkmcnt(7)
    v_mfma_f32_32x32x16_bf16 v[96:111], v[24:27], v[8:11], v[96:111]
    ds_read_b64_tr_b16 v[40:41], v5 offset:28672
    ds_read_b64_tr_b16 v[42:43], v5 offset:29696
    s_waitcnt lgkmcnt(7)
    v_mfma_f32_32x32x16_bf16 v[112:127], v[28:31], v[8:11], v[112:127]
    ds_read_b64_tr_b16 v[44:45], v6 offset:28672
    ds_read_b64_tr_b16 v[46:47], v6 offset:29696
    s_barrier
    s_waitcnt lgkmcnt(6)
    v_mfma_f32_32x32x16_bf16 v[64:79], v[32:35], v[12:15], v[64:79]
    ds_read_b128 v[8:11], v1 offset:32768
    ds_read_b64_tr_b16 v[16:17], v3 offset:32768
    ds_read_b64_tr_b16 v[18:19], v3 offset:33792
    s_waitcnt lgkmcnt(7)
    v_mfma_f32_32x32x16_bf16 v[80:95], v[36:39], v[12:15], v[80:95]
    ds_read_b64_tr_b16 v[20:21], v4 offset:32768
    ds_read_b64_tr_b16 v[22:23], v4 offset:33792
    s_waitcnt lgkmcnt(7)
    v_mfma_f32_32x32x16_bf16 v[96:111], v[40:43], v[12:15], v[96:111]
    ds_read_b64_tr_b16 v[24:25], v5 offset:32768
    ds_read_b64_tr_b16 v[26:27], v5 offset:33792
    s_waitcnt lgkmcnt(7)
    v_mfma_f32_32x32x16_bf16 v[112:127], v[44:47], v[12:15], v[112:127]
    ds_read_b64_tr_b16 v[28:29], v6 offset:32768
    ds_read_b64_tr_b16 v[30:31], v6 offset:33792
    s_waitcnt lgkmcnt(6)
    v_mfma_f32_32x32x16_bf16 v[64:79], v[16:19], v[8:11], v[64:79]
    ds_read_b128 v[12:15], v2 offset:32768
    ds_read_b64_tr_b16 v[32:33], v3 offset:36864
    ds_read_b64_tr_b16 v[34:35], v3 offset:37888
    s_waitcnt lgkmcnt(7)
    v_mfma_f32_32x32x16_bf16 v[80:95], v[20:23], v[8:11], v[80:95]
    ds_read_b64_tr_b16 v[36:37], v4 offset:36864
    ds_read_b64_tr_b16 v[38:39], v4 offset:37888
    s_waitcnt lgkmcnt(7)
    v_mfma_f32_32x32x16_bf16 v[96:111], v[24:27], v[8:11], v[96:111]
    ds_read_b64_tr_b16 v[40:41], v5 offset:36864
    ds_read_b64_tr_b16 v[42:43], v5 offset:37888
    s_waitcnt lgkmcnt(7)
    v_mfma_f32_32x32x16_bf16 v[112:127], v[28:31], v[8:11], v[112:127]
    ds_read_b64_tr_b16 v[44:45], v6 offset:36864
    ds_read_b64_tr_b16 v[46:47], v6 offset:37888
    s_add_u32 s24, s24, 5
    s_cmp_lt_u32 s24, 20
    s_cbranch_scc1 L_gc_loop_1008
    s_waitcnt lgkmcnt(0)
    v_mfma_f32_32x32x16_bf16 v[64:79], v[32:35], v[12:15], v[64:79]
    v_mfma_f32_32x32x16_bf16 v[80:95], v[36:39], v[12:15], v[80:95]
    v_mfma_f32_32x32x16_bf16 v[96:111], v[40:43], v[12:15], v[96:111]
    v_mfma_f32_32x32x16_bf16 v[112:127], v[44:47], v[12:15], v[112:127]
    v_lshlrev_b32 v52, 4, v0
    v_lshlrev_b32 v53, 3, v0
    s_lshl_b32 s25, s40, 2
    s_add_u32 s25, s25, s20
    s_cmp_ge_u32 s41, 5
    s_cbranch_scc1 L_bq_k_1009
    s_lshl_b32 s26, s25, 10
    s_add_u32 s26, s26, 7340032
    s_lshl_b32 s27, s25, 9
    s_add_u32 s27, s27, 9437184
    s_mov_b32 s86, 0x3ea52b5c
    s_mov_b32 s87, 0x3ea52b5c
    s_cmp_eq_u32 s41, 1
    s_cbranch_scc1 L_bq_Q1_1012
    s_cmp_eq_u32 s41, 2
    s_cbranch_scc1 L_bq_Q2_1013
    s_cmp_eq_u32 s41, 3
    s_cbranch_scc1 L_bq_Q3_1014
    s_cmp_eq_u32 s41, 4
    s_cbranch_scc1 L_bq_Q4_1015
    s_nop 7
L_bq_Q0_1011:
    s_nop 7
    s_nop 3
    v_pk_mul_f32 v[64:65], v[64:65], s[86:87]
    v_pk_mul_f32 v[66:67], v[66:67], s[86:87]
    v_cvt_pk_bf16_f32 v56, v64, v65
    v_cvt_pk_bf16_f32 v57, v66, v67
    v_pk_mul_f32 v[68:69], v[68:69], s[86:87]
    v_pk_mul_f32 v[70:71], v[70:71], s[86:87]
    v_cvt_pk_bf16_f32 v58, v68, v69
    v_cvt_pk_bf16_f32 v59, v70, v71
    s_add_u32 s28, s26, 0
    buffer_store_dwordx4 v[56:59], v52, s[16:19], s28 offen
    v_pk_mul_f32 v[72:73], v[72:73], s[86:87]
    v_pk_mul_f32 v[74:75], v[74:75], s[86:87]
    v_cvt_pk_bf16_f32 v60, v72, v73
    v_cvt_pk_bf16_f32 v61, v74, v75
    s_add_u32 s28, s27, 0
    buffer_store_dwordx2 v[60:61], v53, s[16:19], s28 offen
    v_pk_mul_f32 v[76:77], v[76:77], s[86:87]
    v_pk_mul_f32 v[78:79], v[78:79], s[86:87]
    v_cvt_pk_bf16_f32 v56, v76, v77
    v_cvt_pk_bf16_f32 v57, v78, v79
    v_pk_mul_f32 v[80:81], v[80:81], s[86:87]
    v_pk_mul_f32 v[82:83], v[82:83], s[86:87]
    v_cvt_pk_bf16_f32 v58, v80, v81
    v_cvt_pk_bf16_f32 v59, v82, v83
    s_add_u32 s28, s26, 65536
    buffer_store_dwordx4 v[56:59], v52, s[16:19], s28 offen
    v_pk_mul_f32 v[84:85], v[84:85], s[86:87]
    v_pk_mul_f32 v[86:87], v[86:87], s[86:87]
    v_cvt_pk_bf16_f32 v60, v84, v85
    v_cvt_pk_bf16_f32 v61, v86, v87
    v_pk_mul_f32 v[88:89], v[88:89], s[86:87]
    v_pk_mul_f32 v[90:91], v[90:91], s[86:87]
    v_cvt_pk_bf16_f32 v62, v88, v89
    v_cvt_pk_bf16_f32 v63, v90, v91
    s_add_u32 s28, s26, 131072
    buffer_store_dwordx4 v[60:63], v52, s[16:19], s28 offen
    v_pk_mul_f32 v[92:93], v[92:93], s[86:87]
    v_pk_mul_f32 v[94:95], v[94:95], s[86:87]
    v_cvt_pk_bf16_f32 v56, v92, v93
    v_cvt_pk_bf16_f32 v57, v94, v95
    s_add_u32 s28, s27, 32768
    buffer_store_dwordx2 v[56:57], v53, s[16:19], s28 offen
    v_pk_mul_f32 v[96:97], v[96:97], s[86:87]
    v_pk_mul_f32 v[98:99], v[98:99], s[86:87]
    v_cvt_pk_bf16_f32 v60, v96, v97
    v_cvt_pk_bf16_f32 v61, v98, v99
    v_pk_mul_f32 v[100:101], v[100:101], s[86:87]
    v_pk_mul_f32 v[102:103], v[102:103], s[86:87]
    v_cvt_pk_bf16_f32 v62, v100, v101
    v_cvt_pk_bf16_f32 v63, v102, v103
    s_add_u32 s28, s26, 196608
    buffer_store_dwordx4 v[60:63], v52, s[16:19], s28 offen
    v_pk_mul_f32 v[104:105], v[104:105], s[86:87]
    v_pk_mul_f32 v[106:107], v[106:107], s[86:87]
    v_cvt_pk_bf16_f32 v56, v104, v105
    v_cvt_pk_bf16_f32 v57, v106, v107
    v_pk_mul_f32 v[108:109], v[108:109], s[86:87]
    v_pk_mul_f32 v[110:111], v[110:111], s[86:87]
    v_cvt_pk_bf16_f32 v58, v108, v109
    v_cvt_pk_bf16_f32 v59, v110, v111
    s_add_u32 s28, s26, 262144
    buffer_store_dwordx4 v[56:59], v52, s[16:19], s28 offen
    v_pk_mul_f32 v[112:113], v[112:113], s[86:87]
    v_pk_mul_f32 v[114:115], v[114:115], s[86:87]
    v_cvt_pk_bf16_f32 v60, v112, v113
    v_cvt_pk_bf16_f32 v61, v114, v115
    s_add_u32 s28, s27, 65536
    buffer_store_dwordx2 v[60:61], v53, s[16:19], s28 offen
    v_pk_mul_f32 v[116:117], v[116:117], s[86:87]
    v_pk_mul_f32 v[118:119], v[118:119], s[86:87]
    v_cvt_pk_bf16_f32 v56, v116, v117
    v_cvt_pk_bf16_f32 v57, v118, v119
    v_pk_mul_f32 v[120:121], v[120:121], s[86:87]
    v_pk_mul_f32 v[122:123], v[122:123], s[86:87]
    v_cvt_pk_bf16_f32 v58, v120, v121
    v_cvt_pk_bf16_f32 v59, v122, v123
    s_add_u32 s28, s26, 327680
    buffer_store_dwordx4 v[56:59], v52, s[16:19], s28 offen
    v_pk_mul_f32 v[124:125], v[124:125], s[86:87]
    v_pk_mul_f32 v[126:127], v[126:127], s[86:87]
    v_cvt_pk_bf16_f32 v60, v124, v125
    v_cvt_pk_bf16_f32 v61, v126, v127
    s_add_u32 s28, s26, 393216
    buffer_store_dwordx2 v[60:61], v52, s[16:19], s28 offen offset:0
    s_branch L_bq_end_1010
L_bq_Q1_1012:
    s_nop 7
    s_nop 3
    v_pk_mul_f32 v[64:65], v[64:65], s[86:87]
    v_pk_mul_f32 v[66:67], v[66:67], s[86:87]
    v_cvt_pk_bf16_f32 v56, v64, v65
    v_cvt_pk_bf16_f32 v57, v66, v67
    s_add_u32 s28, s26, 393216
    buffer_store_dwordx2 v[56:57], v52, s[16:19], s28 offen offset:8
    v_pk_mul_f32 v[68:69], v[68:69], s[86:87]
    v_pk_mul_f32 v[70:71], v[70:71], s[86:87]
    v_cvt_pk_bf16_f32 v60, v68, v69
    v_cvt_pk_bf16_f32 v61, v70, v71
    s_add_u32 s28, s27, 98304
    buffer_store_dwordx2 v[60:61], v53, s[16:19], s28 offen
    v_pk_mul_f32 v[72:73], v[72:73], s[86:87]
    v_pk_mul_f32 v[74:75], v[74:75], s[86:87]
    v_cvt_pk_bf16_f32 v56, v72, v73
    v_cvt_pk_bf16_f32 v57, v74, v75
    v_pk_mul_f32 v[76:77], v[76:77], s[86:87]
    v_pk_mul_f32 v[78:79], v[78:79], s[86:87]
    v_cvt_pk_bf16_f32 v58, v76, v77
    v_cvt_pk_bf16_f32 v59, v78, v79
    s_add_u32 s28, s26, 458752
    buffer_store_dwordx4 v[56:59], v52, s[16:19], s28 offen
    v_pk_mul_f32 v[80:81], v[80:81], s[86:87]
    v_pk_mul_f32 v[82:83], v[82:83], s[86:87]
    v_cvt_pk_bf16_f32 v60, v80, v81
    v_cvt_pk_bf16_f32 v61, v82, v83
    v_pk_mul_f32 v[84:85], v[84:85], s[86:87]
    v_pk_mul_f32 v[86:87], v[86:87], s[86:87]
    v_cvt_pk_bf16_f32 v62, v84, v85
    v_cvt_pk_bf16_f32 v63, v86, v87
    s_add_u32 s28, s26, 524288
    buffer_store_dwordx4 v[60:63], v52, s[16:19], s28 offen
    v_pk_mul_f32 v[88:89], v[88:89], s[86:87]
    v_pk_mul_f32 v[90:91], v[90:91], s[86:87]
    v_cvt_pk_bf16_f32 v56, v88, v89
    v_cvt_pk_bf16_f32 v57, v90, v91
    s_add_u32 s28, s27, 131072
    buffer_store_dwordx2 v[56:57], v53, s[16:19], s28 offen
    v_pk_mul_f32 v[92:93], v[92:93], s[86:87]
    v_pk_mul_f32 v[94:95], v[94:95], s[86:87]
    v_cvt_pk_bf16_f32 v60, v92, v93
    v_cvt_pk_bf16_f32 v61, v94, v95
    v_pk_mul_f32 v[96:97], v[96:97], s[86:87]
    v_pk_mul_f32 v[98:99], v[98:99], s[86:87]
    v_cvt_pk_bf16_f32 v62, v96, v97
    v_cvt_pk_bf16_f32 v63, v98, v99
    s_add_u32 s28, s26, 589824
    buffer_store_dwordx4 v[60:63], v52, s[16:19], s28 offen
    v_pk_mul_f32 v[100:101], v[100:101], s[86:87]
    v_pk_mul_f32 v[102:103], v[102:103], s[86:87]
    v_cvt_pk_bf16_f32 v56, v100, v101
    v_cvt_pk_bf16_f32 v57, v102, v103
    v_pk_mul_f32 v[104:105], v[104:105], s[86:87]
    v_pk_mul_f32 v[106:107], v[106:107], s[86:87]
    v_cvt_pk_bf16_f32 v58, v104, v105
    v_cvt_pk_bf16_f32 v59, v106, v107
    s_add_u32 s28, s26, 655360
    buffer_store_dwordx4 v[56:59], v52, s[16:19], s28 offen
    v_pk_mul_f32 v[108:109], v[108:109], s[86:87]
    v_pk_mul_f32 v[110:111], v[110:111], s[86:87]
    v_cvt_pk_bf16_f32 v60, v108, v109
    v_cvt_pk_bf16_f32 v61, v110, v111
    s_add_u32 s28, s27, 163840
    buffer_store_dwordx2 v[60:61], v53, s[16:19], s28 offen
    v_pk_mul_f32 v[112:113], v[112:113], s[86:87]
    v_pk_mul_f32 v[114:115], v[114:115], s[86:87]
    v_cvt_pk_bf16_f32 v56, v112, v113
    v_cvt_pk_bf16_f32 v57, v114, v115
    v_pk_mul_f32 v[116:117], v[116:117], s[86:87]
    v_pk_mul_f32 v[118:119], v[118:119], s[86:87]
    v_cvt_pk_bf16_f32 v58, v116, v117
    v_cvt_pk_bf16_f32 v59, v118, v119
    s_add_u32 s28, s26, 720896
    buffer_store_dwordx4 v[56:59], v52, s[16:19], s28 offen
    v_pk_mul_f32 v[120:121], v[120:121], s[86:87]
    v_pk_mul_f32 v[122:123], v[122:123], s[86:87]
    v_cvt_pk_bf16_f32 v60, v120, v121
    v_cvt_pk_bf16_f32 v61, v122, v123
    v_pk_mul_f32 v[124:125], v[124:125], s[86:87]
    v_pk_mul_f32 v[126:127], v[126:127], s[86:87]
    v_cvt_pk_bf16_f32 v62, v124, v125
    v_cvt_pk_bf16_f32 v63, v126, v127
    s_add_u32 s28, s26, 786432
    buffer_store_dwordx4 v[60:63], v52, s[16:19], s28 offen
    s_branch L_bq_end_1010
L_bq_Q2_1013:
    s_nop 7
    s_nop 3
    v_pk_mul_f32 v[64:65], v[64:65], s[86:87]
    v_pk_mul_f32 v[66:67], v[66:67], s[86:87]
    v_cvt_pk_bf16_f32 v56, v64, v65
    v_cvt_pk_bf16_f32 v57, v66, v67
    s_add_u32 s28, s27, 196608
    buffer_store_dwordx2 v[56:57], v53, s[16:19], s28 offen
    v_pk_mul_f32 v[68:69], v[68:69], s[86:87]
    v_pk_mul_f32 v[70:71], v[70:71], s[86:87]
    v_cvt_pk_bf16_f32 v60, v68, v69
    v_cvt_pk_bf16_f32 v61, v70, v71
    v_pk_mul_f32 v[72:73], v[72:73], s[86:87]
    v_pk_mul_f32 v[74:75], v[74:75], s[86:87]
    v_cvt_pk_bf16_f32 v62, v72, v73
    v_cvt_pk_bf16_f32 v63, v74, v75
    s_add_u32 s28, s26, 851968
    buffer_store_dwordx4 v[60:63], v52, s[16:19], s28 offen
    v_pk_mul_f32 v[76:77], v[76:77], s[86:87]
    v_pk_mul_f32 v[78:79], v[78:79], s[86:87]
    v_cvt_pk_bf16_f32 v56, v76, v77
    v_cvt_pk_bf16_f32 v57, v78, v79
    v_pk_mul_f32 v[80:81], v[80:81], s[86:87]
    v_pk_mul_f32 v[82:83], v[82:83], s[86:87]
    v_cvt_pk_bf16_f32 v58, v80, v81
    v_cvt_pk_bf16_f32 v59, v82, v83
    s_add_u32 s28, s26, 917504
    buffer_store_dwordx4 v[56:59], v52, s[16:19], s28 offen
    v_pk_mul_f32 v[84:85], v[84:85], s[86:87]
    v_pk_mul_f32 v[86:87], v[86:87], s[86:87]
    v_cvt_pk_bf16_f32 v60, v84, v85
    v_cvt_pk_bf16_f32 v61, v86, v87
    s_add_u32 s28, s27, 229376
    buffer_store_dwordx2 v[60:61], v53, s[16:19], s28 offen
    v_pk_mul_f32 v[88:89], v[88:89], s[86:87]
    v_pk_mul_f32 v[90:91], v[90:91], s[86:87]
    v_cvt_pk_bf16_f32 v56, v88, v89
    v_cvt_pk_bf16_f32 v57, v90, v91
    v_pk_mul_f32 v[92:93], v[92:93], s[86:87]
    v_pk_mul_f32 v[94:95], v[94:95], s[86:87]
    v_cvt_pk_bf16_f32 v58, v92, v93
    v_cvt_pk_bf16_f32 v59, v94, v95
    s_add_u32 s28, s26, 983040
    buffer_store_dwordx4 v[56:59], v52, s[16:19], s28 offen
    v_pk_mul_f32 v[96:97], v[96:97], s[86:87]
    v_pk_mul_f32 v[98:99], v[98:99], s[86:87]
    v_cvt_pk_bf16_f32 v60, v96, v97
    v_cvt_pk_bf16_f32 v61, v98, v99
    v_pk_mul_f32 v[100:101], v[100:101], s[86:87]
    v_pk_mul_f32 v[102:103], v[102:103], s[86:87]
    v_cvt_pk_bf16_f32 v62, v100, v101
    v_cvt_pk_bf16_f32 v63, v102, v103
    s_add_u32 s28, s26, 1048576
    buffer_store_dwordx4 v[60:63], v52, s[16:19], s28 offen
    v_pk_mul_f32 v[104:105], v[104:105], s[86:87]
    v_pk_mul_f32 v[106:107], v[106:107], s[86:87]
    v_cvt_pk_bf16_f32 v56, v104, v105
    v_cvt_pk_bf16_f32 v57, v106, v107
    s_add_u32 s28, s27, 262144
    buffer_store_dwordx2 v[56:57], v53, s[16:19], s28 offen
    v_pk_mul_f32 v[108:109], v[108:109], s[86:87]
    v_pk_mul_f32 v[110:111], v[110:111], s[86:87]
    v_cvt_pk_bf16_f32 v60, v108, v109
    v_cvt_pk_bf16_f32 v61, v110, v111
    v_pk_mul_f32 v[112:113], v[112:113], s[86:87]
    v_pk_mul_f32 v[114:115], v[114:115], s[86:87]
    v_cvt_pk_bf16_f32 v62, v112, v113
    v_cvt_pk_bf16_f32 v63, v114, v115
    s_add_u32 s28, s26, 1114112
    buffer_store_dwordx4 v[60:63], v52, s[16:19], s28 offen
    v_pk_mul_f32 v[116:117], v[116:117], s[86:87]
    v_pk_mul_f32 v[118:119], v[118:119], s[86:87]
    v_cvt_pk_bf16_f32 v56, v116, v117
    v_cvt_pk_bf16_f32 v57, v118, v119
    v_pk_mul_f32 v[120:121], v[120:121], s[86:87]
    v_pk_mul_f32 v[122:123], v[122:123], s[86:87]
    v_cvt_pk_bf16_f32 v58, v120, v121
    v_cvt_pk_bf16_f32 v59, v122, v123
    s_add_u32 s28, s26, 1179648
    buffer_store_dwordx4 v[56:59], v52, s[16:19], s28 offen
    v_pk_mul_f32 v[124:125], v[124:125], s[86:87]
    v_pk_mul_f32 v[126:127], v[126:127], s[86:87]
    v_cvt_pk_bf16_f32 v60, v124, v125
    v_cvt_pk_bf16_f32 v61, v126, v127
    s_add_u32 s28, s27, 294912
    buffer_store_dwordx2 v[60:61], v53, s[16:19], s28 offen
    s_branch L_bq_end_1010
L_bq_Q3_1014:
    s_nop 7
    s_nop 3
    v_pk_mul_f32 v[64:65], v[64:65], s[86:87]
    v_pk_mul_f32 v[66:67], v[66:67], s[86:87]
    v_cvt_pk_bf16_f32 v56, v64, v65
    v_cvt_pk_bf16_f32 v57, v66, v67
    v_pk_mul_f32 v[68:69], v[68:69], s[86:87]
    v_pk_mul_f32 v[70:71], v[70:71], s[86:87]
    v_cvt_pk_bf16_f32 v58, v68, v69
    v_cvt_pk_bf16_f32 v59, v70, v71
    s_add_u32 s28, s26, 1245184
    buffer_store_dwordx4 v[56:59], v52, s[16:19], s28 offen
    v_pk_mul_f32 v[72:73], v[72:73], s[86:87]
    v_pk_mul_f32 v[74:75], v[74:75], s[86:87]
    v_cvt_pk_bf16_f32 v60, v72, v73
    v_cvt_pk_bf16_f32 v61, v74, v75
    v_pk_mul_f32 v[76:77], v[76:77], s[86:87]
    v_pk_mul_f32 v[78:79], v[78:79], s[86:87]
    v_cvt_pk_bf16_f32 v62, v76, v77
    v_cvt_pk_bf16_f32 v63, v78, v79
    s_add_u32 s28, s26, 1310720
    buffer_store_dwordx4 v[60:63], v52, s[16:19], s28 offen
    v_pk_mul_f32 v[80:81], v[80:81], s[86:87]
    v_pk_mul_f32 v[82:83], v[82:83], s[86:87]
    v_cvt_pk_bf16_f32 v56, v80, v81
    v_cvt_pk_bf16_f32 v57, v82, v83
    s_add_u32 s28, s27, 327680
    buffer_store_dwordx2 v[56:57], v53, s[16:19], s28 offen
    v_pk_mul_f32 v[84:85], v[84:85], s[86:87]
    v_pk_mul_f32 v[86:87], v[86:87], s[86:87]
    v_cvt_pk_bf16_f32 v60, v84, v85
    v_cvt_pk_bf16_f32 v61, v86, v87
    v_pk_mul_f32 v[88:89], v[88:89], s[86:87]
    v_pk_mul_f32 v[90:91], v[90:91], s[86:87]
    v_cvt_pk_bf16_f32 v62, v88, v89
    v_cvt_pk_bf16_f32 v63, v90, v91
    s_add_u32 s28, s26, 1376256
    buffer_store_dwordx4 v[60:63], v52, s[16:19], s28 offen
    v_pk_mul_f32 v[92:93], v[92:93], s[86:87]
    v_pk_mul_f32 v[94:95], v[94:95], s[86:87]
    v_cvt_pk_bf16_f32 v56, v92, v93
    v_cvt_pk_bf16_f32 v57, v94, v95
    v_pk_mul_f32 v[96:97], v[96:97], s[86:87]
    v_pk_mul_f32 v[98:99], v[98:99], s[86:87]
    v_cvt_pk_bf16_f32 v58, v96, v97
    v_cvt_pk_bf16_f32 v59, v98, v99
    s_add_u32 s28, s26, 1441792
    buffer_store_dwordx4 v[56:59], v52, s[16:19], s28 offen
    v_pk_mul_f32 v[100:101], v[100:101], s[86:87]
    v_pk_mul_f32 v[102:103], v[102:103], s[86:87]
    v_cvt_pk_bf16_f32 v60, v100, v101
    v_cvt_pk_bf16_f32 v61, v102, v103
    s_add_u32 s28, s27, 360448
    buffer_store_dwordx2 v[60:61], v53, s[16:19], s28 offen
    v_pk_mul_f32 v[104:105], v[104:105], s[86:87]
    v_pk_mul_f32 v[106:107], v[106:107], s[86:87]
    v_cvt_pk_bf16_f32 v56, v104, v105
    v_cvt_pk_bf16_f32 v57, v106, v107
    v_pk_mul_f32 v[108:109], v[108:109], s[86:87]
    v_pk_mul_f32 v[110:111], v[110:111], s[86:87]
    v_cvt_pk_bf16_f32 v58, v108, v109
    v_cvt_pk_bf16_f32 v59, v110, v111
    s_add_u32 s28, s26, 1507328
    buffer_store_dwordx4 v[56:59], v52, s[16:19], s28 offen
    v_pk_mul_f32 v[112:113], v[112:113], s[86:87]
    v_pk_mul_f32 v[114:115], v[114:115], s[86:87]
    v_cvt_pk_bf16_f32 v60, v112, v113
    v_cvt_pk_bf16_f32 v61, v114, v115
    v_pk_mul_f32 v[116:117], v[116:117], s[86:87]
    v_pk_mul_f32 v[118:119], v[118:119], s[86:87]
    v_cvt_pk_bf16_f32 v62, v116, v117
    v_cvt_pk_bf16_f32 v63, v118, v119
    s_add_u32 s28, s26, 1572864
    buffer_store_dwordx4 v[60:63], v52, s[16:19], s28 offen
    v_pk_mul_f32 v[120:121], v[120:121], s[86:87]
    v_pk_mul_f32 v[122:123], v[122:123], s[86:87]
    v_cvt_pk_bf16_f32 v56, v120, v121
    v_cvt_pk_bf16_f32 v57, v122, v123
    s_add_u32 s28, s27, 393216
    buffer_store_dwordx2 v[56:57], v53, s[16:19], s28 offen
    v_pk_mul_f32 v[124:125], v[124:125], s[86:87]
    v_pk_mul_f32 v[126:127], v[126:127], s[86:87]
    v_cvt_pk_bf16_f32 v60, v124, v125
    v_cvt_pk_bf16_f32 v61, v126, v127
    s_add_u32 s28, s26, 1638400
    buffer_store_dwordx2 v[60:61], v52, s[16:19], s28 offen offset:0
    s_branch L_bq_end_1010
L_bq_Q4_1015:
    s_nop 7
    s_nop 3
    v_pk_mul_f32 v[64:65], v[64:65], s[86:87]
    v_pk_mul_f32 v[66:67], v[66:67], s[86:87]
    v_cvt_pk_bf16_f32 v56, v64, v65
    v_cvt_pk_bf16_f32 v57, v66, v67
    s_add_u32 s28, s26, 1638400
    buffer_store_dwordx2 v[56:57], v52, s[16:19], s28 offen offset:8
    v_pk_mul_f32 v[68:69], v[68:69], s[86:87]
    v_pk_mul_f32 v[70:71], v[70:71], s[86:87]
    v_cvt_pk_bf16_f32 v60, v68, v69
    v_cvt_pk_bf16_f32 v61, v70, v71
    v_pk_mul_f32 v[72:73], v[72:73], s[86:87]
    v_pk_mul_f32 v[74:75], v[74:75], s[86:87]
    v_cvt_pk_bf16_f32 v62, v72, v73
    v_cvt_pk_bf16_f32 v63, v74, v75
    s_add_u32 s28, s26, 1703936
    buffer_store_dwordx4 v[60:63], v52, s[16:19], s28 offen
    v_pk_mul_f32 v[76:77], v[76:77], s[86:87]
    v_pk_mul_f32 v[78:79], v[78:79], s[86:87]
    v_cvt_pk_bf16_f32 v56, v76, v77
    v_cvt_pk_bf16_f32 v57, v78, v79
    s_add_u32 s28, s27, 425984
    buffer_store_dwordx2 v[56:57], v53, s[16:19], s28 offen
    v_pk_mul_f32 v[80:81], v[80:81], s[86:87]
    v_pk_mul_f32 v[82:83], v[82:83], s[86:87]
    v_cvt_pk_bf16_f32 v60, v80, v81
    v_cvt_pk_bf16_f32 v61, v82, v83
    v_pk_mul_f32 v[84:85], v[84:85], s[86:87]
    v_pk_mul_f32 v[86:87], v[86:87], s[86:87]
    v_cvt_pk_bf16_f32 v62, v84, v85
    v_cvt_pk_bf16_f32 v63, v86, v87
    s_add_u32 s28, s26, 1769472
    buffer_store_dwordx4 v[60:63], v52, s[16:19], s28 offen
    v_pk_mul_f32 v[88:89], v[88:89], s[86:87]
    v_pk_mul_f32 v[90:91], v[90:91], s[86:87]
    v_cvt_pk_bf16_f32 v56, v88, v89
    v_cvt_pk_bf16_f32 v57, v90, v91
    v_pk_mul_f32 v[92:93], v[92:93], s[86:87]
    v_pk_mul_f32 v[94:95], v[94:95], s[86:87]
    v_cvt_pk_bf16_f32 v58, v92, v93
    v_cvt_pk_bf16_f32 v59, v94, v95
    s_add_u32 s28, s26, 1835008
    buffer_store_dwordx4 v[56:59], v52, s[16:19], s28 offen
    v_pk_mul_f32 v[96:97], v[96:97], s[86:87]
    v_pk_mul_f32 v[98:99], v[98:99], s[86:87]
    v_cvt_pk_bf16_f32 v60, v96, v97
    v_cvt_pk_bf16_f32 v61, v98, v99
    s_add_u32 s28, s27, 458752
    buffer_store_dwordx2 v[60:61], v53, s[16:19], s28 offen
    v_pk_mul_f32 v[100:101], v[100:101], s[86:87]
    v_pk_mul_f32 v[102:103], v[102:103], s[86:87]
    v_cvt_pk_bf16_f32 v56, v100, v101
    v_cvt_pk_bf16_f32 v57, v102, v103
    v_pk_mul_f32 v[104:105], v[104:105], s[86:87]
    v_pk_mul_f32 v[106:107], v[106:107], s[86:87]
    v_cvt_pk_bf16_f32 v58, v104, v105
    v_cvt_pk_bf16_f32 v59, v106, v107
    s_add_u32 s28, s26, 1900544
    buffer_store_dwordx4 v[56:59], v52, s[16:19], s28 offen
    v_pk_mul_f32 v[108:109], v[108:109], s[86:87]
    v_pk_mul_f32 v[110:111], v[110:111], s[86:87]
    v_cvt_pk_bf16_f32 v60, v108, v109
    v_cvt_pk_bf16_f32 v61, v110, v111
    v_pk_mul_f32 v[112:113], v[112:113], s[86:87]
    v_pk_mul_f32 v[114:115], v[114:115], s[86:87]
    v_cvt_pk_bf16_f32 v62, v112, v113
    v_cvt_pk_bf16_f32 v63, v114, v115
    s_add_u32 s28, s26, 1966080
    buffer_store_dwordx4 v[60:63], v52, s[16:19], s28 offen
    v_pk_mul_f32 v[116:117], v[116:117], s[86:87]
    v_pk_mul_f32 v[118:119], v[118:119], s[86:87]
    v_cvt_pk_bf16_f32 v56, v116, v117
    v_cvt_pk_bf16_f32 v57, v118, v119
    s_add_u32 s28, s27, 491520
    buffer_store_dwordx2 v[56:57], v53, s[16:19], s28 offen
    v_pk_mul_f32 v[120:121], v[120:121], s[86:87]
    v_pk_mul_f32 v[122:123], v[122:123], s[86:87]
    v_cvt_pk_bf16_f32 v60, v120, v121
    v_cvt_pk_bf16_f32 v61, v122, v123
    v_pk_mul_f32 v[124:125], v[124:125], s[86:87]
    v_pk_mul_f32 v[126:127], v[126:127], s[86:87]
    v_cvt_pk_bf16_f32 v62, v124, v125
    v_cvt_pk_bf16_f32 v63, v126, v127
    s_add_u32 s28, s26, 2031616
    buffer_store_dwordx4 v[60:63], v52, s[16:19], s28 offen
    s_branch L_bq_end_1010
L_bq_k_1009:
    s_sub_u32 s41, s41, 5
    s_add_u32 s25, s25, 63
    s_and_b32 s25, s25, 63
    s_mul_i32 s26, s25, 2304
    s_add_u32 s26, s26, 4096
    s_lshl_b32 s27, s25, 9
    s_add_u32 s27, s27, 5242880
    s_cmp_eq_u32 s41, 1
    s_cbranch_scc1 L_bq_K1_1017
    s_cmp_eq_u32 s41, 2
    s_cbranch_scc1 L_bq_K2_1018
    s_cmp_eq_u32 s41, 3
    s_cbranch_scc1 L_bq_K3_1019
    s_cmp_eq_u32 s41, 4
    s_cbranch_scc1 L_bq_K4_1020
    s_nop 7
L_bq_K0_1016:
    s_nop 7
    s_nop 3
    v_cvt_pk_bf16_f32 v56, v64, v65
    v_cvt_pk_bf16_f32 v57, v66, v67
    v_cvt_pk_bf16_f32 v58, v68, v69
    v_cvt_pk_bf16_f32 v59, v70, v71
    s_add_u32 s28, s26, 0
    buffer_store_dwordx4 v[56:59], v52, s[16:19], s28 offen
    v_cvt_pk_bf16_f32 v60, v72, v73
    v_cvt_pk_bf16_f32 v61, v74, v75
    s_add_u32 s28, s27, 0
    buffer_store_dwordx2 v[60:61], v53, s[16:19], s28 offen
    v_cvt_pk_bf16_f32 v56, v76, v77
    v_cvt_pk_bf16_f32 v57, v78, v79
    v_cvt_pk_bf16_f32 v58, v80, v81
    v_cvt_pk_bf16_f32 v59, v82, v83
    s_add_u32 s28, s26, 147456
    buffer_store_dwordx4 v[56:59], v52, s[16:19], s28 offen
    v_cvt_pk_bf16_f32 v60, v84, v85
    v_cvt_pk_bf16_f32 v61, v86, v87
    v_cvt_pk_bf16_f32 v62, v88, v89
    v_cvt_pk_bf16_f32 v63, v90, v91
    s_add_u32 s28, s26, 294912
    buffer_store_dwordx4 v[60:63], v52, s[16:19], s28 offen
    v_cvt_pk_bf16_f32 v56, v92, v93
    v_cvt_pk_bf16_f32 v57, v94, v95
    s_add_u32 s28, s27, 32768
    buffer_store_dwordx2 v[56:57], v53, s[16:19], s28 offen
    v_cvt_pk_bf16_f32 v60, v96, v97
    v_cvt_pk_bf16_f32 v61, v98, v99
    v_cvt_pk_bf16_f32 v62, v100, v101
    v_cvt_pk_bf16_f32 v63, v102, v103
    s_add_u32 s28, s26, 442368
    buffer_store_dwordx4 v[60:63], v52, s[16:19], s28 offen
    v_cvt_pk_bf16_f32 v56, v104, v105
    v_cvt_pk_bf16_f32 v57, v106, v107
    v_cvt_pk_bf16_f32 v58, v108, v109
    v_cvt_pk_bf16_f32 v59, v110, v111
    s_add_u32 s28, s26, 589824
    buffer_store_dwordx4 v[56:59], v52, s[16:19], s28 offen
    v_cvt_pk_bf16_f32 v60, v112, v113
    v_cvt_pk_bf16_f32 v61, v114, v115
    s_add_u32 s28, s27, 65536
    buffer_store_dwordx2 v[60:61], v53, s[16:19], s28 offen
    v_cvt_pk_bf16_f32 v56, v116, v117
    v_cvt_pk_bf16_f32 v57, v118, v119
    v_cvt_pk_bf16_f32 v58, v120, v121
    v_cvt_pk_bf16_f32 v59, v122, v123
    s_add_u32 s28, s26, 737280
    buffer_store_dwordx4 v[56:59], v52, s[16:19], s28 offen
    v_cvt_pk_bf16_f32 v60, v124, v125
    v_cvt_pk_bf16_f32 v61, v126, v127
    s_add_u32 s28, s26, 884736
    buffer_store_dwordx2 v[60:61], v52, s[16:19], s28 offen offset:0
    s_branch L_bq_end_1010
L_bq_K1_1017:
    s_nop 7
    s_nop 3
    v_cvt_pk_bf16_f32 v56, v64, v65
    v_cvt_pk_bf16_f32 v57, v66, v67
    s_add_u32 s28, s26, 884736
    buffer_store_dwordx2 v[56:57], v52, s[16:19], s28 offen offset:8
    v_cvt_pk_bf16_f32 v60, v68, v69
    v_cvt_pk_bf16_f32 v61, v70, v71
    s_add_u32 s28, s27, 98304
    buffer_store_dwordx2 v[60:61], v53, s[16:19], s28 offen
    v_cvt_pk_bf16_f32 v56, v72, v73
    v_cvt_pk_bf16_f32 v57, v74, v75
    v_cvt_pk_bf16_f32 v58, v76, v77
    v_cvt_pk_bf16_f32 v59, v78, v79
    s_add_u32 s28, s26, 1032192
    buffer_store_dwordx4 v[56:59], v52, s[16:19], s28 offen
    v_cvt_pk_bf16_f32 v60, v80, v81
    v_cvt_pk_bf16_f32 v61, v82, v83
    v_cvt_pk_bf16_f32 v62, v84, v85
    v_cvt_pk_bf16_f32 v63, v86, v87
    s_add_u32 s28, s26, 1179648
    buffer_store_dwordx4 v[60:63], v52, s[16:19], s28 offen
    v_cvt_pk_bf16_f32 v56, v88, v89
    v_cvt_pk_bf16_f32 v57, v90, v91
    s_add_u32 s28, s27, 131072
    buffer_store_dwordx2 v[56:57], v53, s[16:19], s28 offen
    v_cvt_pk_bf16_f32 v60, v92, v93
    v_cvt_pk_bf16_f32 v61, v94, v95
    v_cvt_pk_bf16_f32 v62, v96, v97
    v_cvt_pk_bf16_f32 v63, v98, v99
    s_add_u32 s28, s26, 1327104
    buffer_store_dwordx4 v[60:63], v52, s[16:19], s28 offen
    v_cvt_pk_bf16_f32 v56, v100, v101
    v_cvt_pk_bf16_f32 v57, v102, v103
    v_cvt_pk_bf16_f32 v58, v104, v105
    v_cvt_pk_bf16_f32 v59, v106, v107
    s_add_u32 s28, s26, 1474560
    buffer_store_dwordx4 v[56:59], v52, s[16:19], s28 offen
    v_cvt_pk_bf16_f32 v60, v108, v109
    v_cvt_pk_bf16_f32 v61, v110, v111
    s_add_u32 s28, s27, 163840
    buffer_store_dwordx2 v[60:61], v53, s[16:19], s28 offen
    v_cvt_pk_bf16_f32 v56, v112, v113
    v_cvt_pk_bf16_f32 v57, v114, v115
    v_cvt_pk_bf16_f32 v58, v116, v117
    v_cvt_pk_bf16_f32 v59, v118, v119
    s_add_u32 s28, s26, 1622016
    buffer_store_dwordx4 v[56:59], v52, s[16:19], s28 offen
    v_cvt_pk_bf16_f32 v60, v120, v121
    v_cvt_pk_bf16_f32 v61, v122, v123
    v_cvt_pk_bf16_f32 v62, v124, v125
    v_cvt_pk_bf16_f32 v63, v126, v127
    s_add_u32 s28, s26, 1769472
    buffer_store_dwordx4 v[60:63], v52, s[16:19], s28 offen
    s_branch L_bq_end_1010
L_bq_K2_1018:
    s_nop 7
    s_nop 3
    v_cvt_pk_bf16_f32 v56, v64, v65
    v_cvt_pk_bf16_f32 v57, v66, v67
    s_add_u32 s28, s27, 196608
    buffer_store_dwordx2 v[56:57], v53, s[16:19], s28 offen
    v_cvt_pk_bf16_f32 v60, v68, v69
    v_cvt_pk_bf16_f32 v61, v70, v71
    v_cvt_pk_bf16_f32 v62, v72, v73
    v_cvt_pk_bf16_f32 v63, v74, v75
    s_add_u32 s28, s26, 1916928
    buffer_store_dwordx4 v[60:63], v52, s[16:19], s28 offen
    v_cvt_pk_bf16_f32 v56, v76, v77
    v_cvt_pk_bf16_f32 v57, v78, v79
    v_cvt_pk_bf16_f32 v58, v80, v81
    v_cvt_pk_bf16_f32 v59, v82, v83
    s_add_u32 s28, s26, 2064384
    buffer_store_dwordx4 v[56:59], v52, s[16:19], s28 offen
    v_cvt_pk_bf16_f32 v60, v84, v85
    v_cvt_pk_bf16_f32 v61, v86, v87
    s_add_u32 s28, s27, 229376
    buffer_store_dwordx2 v[60:61], v53, s[16:19], s28 offen
    v_cvt_pk_bf16_f32 v56, v88, v89
    v_cvt_pk_bf16_f32 v57, v90, v91
    v_cvt_pk_bf16_f32 v58, v92, v93
    v_cvt_pk_bf16_f32 v59, v94, v95
    s_add_u32 s28, s26, 2211840
    buffer_store_dwordx4 v[56:59], v52, s[16:19], s28 offen
    v_cvt_pk_bf16_f32 v60, v96, v97
    v_cvt_pk_bf16_f32 v61, v98, v99
    v_cvt_pk_bf16_f32 v62, v100, v101
    v_cvt_pk_bf16_f32 v63, v102, v103
    s_add_u32 s28, s26, 2359296
    buffer_store_dwordx4 v[60:63], v52, s[16:19], s28 offen
    v_cvt_pk_bf16_f32 v56, v104, v105
    v_cvt_pk_bf16_f32 v57, v106, v107
    s_add_u32 s28, s27, 262144
    buffer_store_dwordx2 v[56:57], v53, s[16:19], s28 offen
    v_cvt_pk_bf16_f32 v60, v108, v109
    v_cvt_pk_bf16_f32 v61, v110, v111
    v_cvt_pk_bf16_f32 v62, v112, v113
    v_cvt_pk_bf16_f32 v63, v114, v115
    s_add_u32 s28, s26, 2506752
    buffer_store_dwordx4 v[60:63], v52, s[16:19], s28 offen
    v_cvt_pk_bf16_f32 v56, v116, v117
    v_cvt_pk_bf16_f32 v57, v118, v119
    v_cvt_pk_bf16_f32 v58, v120, v121
    v_cvt_pk_bf16_f32 v59, v122, v123
    s_add_u32 s28, s26, 2654208
    buffer_store_dwordx4 v[56:59], v52, s[16:19], s28 offen
    v_cvt_pk_bf16_f32 v60, v124, v125
    v_cvt_pk_bf16_f32 v61, v126, v127
    s_add_u32 s28, s27, 294912
    buffer_store_dwordx2 v[60:61], v53, s[16:19], s28 offen
    s_branch L_bq_end_1010
L_bq_K3_1019:
    s_nop 7
    s_nop 3
    v_cvt_pk_bf16_f32 v56, v64, v65
    v_cvt_pk_bf16_f32 v57, v66, v67
    v_cvt_pk_bf16_f32 v58, v68, v69
    v_cvt_pk_bf16_f32 v59, v70, v71
    s_add_u32 s28, s26, 2801664
    buffer_store_dwordx4 v[56:59], v52, s[16:19], s28 offen
    v_cvt_pk_bf16_f32 v60, v72, v73
    v_cvt_pk_bf16_f32 v61, v74, v75
    v_cvt_pk_bf16_f32 v62, v76, v77
    v_cvt_pk_bf16_f32 v63, v78, v79
    s_add_u32 s28, s26, 2949120
    buffer_store_dwordx4 v[60:63], v52, s[16:19], s28 offen
    v_cvt_pk_bf16_f32 v56, v80, v81
    v_cvt_pk_bf16_f32 v57, v82, v83
    s_add_u32 s28, s27, 327680
    buffer_store_dwordx2 v[56:57], v53, s[16:19], s28 offen
    v_cvt_pk_bf16_f32 v60, v84, v85
    v_cvt_pk_bf16_f32 v61, v86, v87
    v_cvt_pk_bf16_f32 v62, v88, v89
    v_cvt_pk_bf16_f32 v63, v90, v91
    s_add_u32 s28, s26, 3096576
    buffer_store_dwordx4 v[60:63], v52, s[16:19], s28 offen
    v_cvt_pk_bf16_f32 v56, v92, v93
    v_cvt_pk_bf16_f32 v57, v94, v95
    v_cvt_pk_bf16_f32 v58, v96, v97
    v_cvt_pk_bf16_f32 v59, v98, v99
    s_add_u32 s28, s26, 3244032
    buffer_store_dwordx4 v[56:59], v52, s[16:19], s28 offen
    v_cvt_pk_bf16_f32 v60, v100, v101
    v_cvt_pk_bf16_f32 v61, v102, v103
    s_add_u32 s28, s27, 360448
    buffer_store_dwordx2 v[60:61], v53, s[16:19], s28 offen
    v_cvt_pk_bf16_f32 v56, v104, v105
    v_cvt_pk_bf16_f32 v57, v106, v107
    v_cvt_pk_bf16_f32 v58, v108, v109
    v_cvt_pk_bf16_f32 v59, v110, v111
    s_add_u32 s28, s26, 3391488
    buffer_store_dwordx4 v[56:59], v52, s[16:19], s28 offen
    v_cvt_pk_bf16_f32 v60, v112, v113
    v_cvt_pk_bf16_f32 v61, v114, v115
    v_cvt_pk_bf16_f32 v62, v116, v117
    v_cvt_pk_bf16_f32 v63, v118, v119
    s_add_u32 s28, s26, 3538944
    buffer_store_dwordx4 v[60:63], v52, s[16:19], s28 offen
    v_cvt_pk_bf16_f32 v56, v120, v121
    v_cvt_pk_bf16_f32 v57, v122, v123
    s_add_u32 s28, s27, 393216
    buffer_store_dwordx2 v[56:57], v53, s[16:19], s28 offen
    v_cvt_pk_bf16_f32 v60, v124, v125
    v_cvt_pk_bf16_f32 v61, v126, v127
    s_add_u32 s28, s26, 3686400
    buffer_store_dwordx2 v[60:61], v52, s[16:19], s28 offen offset:0
    s_branch L_bq_end_1010
L_bq_K4_1020:
    s_nop 7
    s_nop 3
    v_cvt_pk_bf16_f32 v56, v64, v65
    v_cvt_pk_bf16_f32 v57, v66, v67
    s_add_u32 s28, s26, 3686400
    buffer_store_dwordx2 v[56:57], v52, s[16:19], s28 offen offset:8
    v_cvt_pk_bf16_f32 v60, v68, v69
    v_cvt_pk_bf16_f32 v61, v70, v71
    v_cvt_pk_bf16_f32 v62, v72, v73
    v_cvt_pk_bf16_f32 v63, v74, v75
    s_add_u32 s28, s26, 3833856
    buffer_store_dwordx4 v[60:63], v52, s[16:19], s28 offen
    v_cvt_pk_bf16_f32 v56, v76, v77
    v_cvt_pk_bf16_f32 v57, v78, v79
    s_add_u32 s28, s27, 425984
    buffer_store_dwordx2 v[56:57], v53, s[16:19], s28 offen
    v_cvt_pk_bf16_f32 v60, v80, v81
    v_cvt_pk_bf16_f32 v61, v82, v83
    v_cvt_pk_bf16_f32 v62, v84, v85
    v_cvt_pk_bf16_f32 v63, v86, v87
    s_add_u32 s28, s26, 3981312
    buffer_store_dwordx4 v[60:63], v52, s[16:19], s28 offen
    v_cvt_pk_bf16_f32 v56, v88, v89
    v_cvt_pk_bf16_f32 v57, v90, v91
    v_cvt_pk_bf16_f32 v58, v92, v93
    v_cvt_pk_bf16_f32 v59, v94, v95
    s_add_u32 s28, s26, 4128768
    buffer_store_dwordx4 v[56:59], v52, s[16:19], s28 offen
    v_cvt_pk_bf16_f32 v60, v96, v97
    v_cvt_pk_bf16_f32 v61, v98, v99
    s_add_u32 s28, s27, 458752
    buffer_store_dwordx2 v[60:61], v53, s[16:19], s28 offen
    v_cvt_pk_bf16_f32 v56, v100, v101
    v_cvt_pk_bf16_f32 v57, v102, v103
    v_cvt_pk_bf16_f32 v58, v104, v105
    v_cvt_pk_bf16_f32 v59, v106, v107
    s_add_u32 s28, s26, 4276224
    buffer_store_dwordx4 v[56:59], v52, s[16:19], s28 offen
    v_cvt_pk_bf16_f32 v60, v108, v109
    v_cvt_pk_bf16_f32 v61, v110, v111
    v_cvt_pk_bf16_f32 v62, v112, v113
    v_cvt_pk_bf16_f32 v63, v114, v115
    s_add_u32 s28, s26, 4423680
    buffer_store_dwordx4 v[60:63], v52, s[16:19], s28 offen
    v_cvt_pk_bf16_f32 v56, v116, v117
    v_cvt_pk_bf16_f32 v57, v118, v119
    s_add_u32 s28, s27, 491520
    buffer_store_dwordx2 v[56:57], v53, s[16:19], s28 offen
    v_cvt_pk_bf16_f32 v60, v120, v121
    v_cvt_pk_bf16_f32 v61, v122, v123
    v_cvt_pk_bf16_f32 v62, v124, v125
    v_cvt_pk_bf16_f32 v63, v126, v127
    s_add_u32 s28, s26, 4571136
    buffer_store_dwordx4 v[60:63], v52, s[16:19], s28 offen
    s_branch L_bq_end_1010
L_bq_v_1007:
    v_mov_b32 v64, 0
    v_mov_b32 v65, 0
    v_mov_b32 v66, 0
    v_mov_b32 v67, 0
    v_mov_b32 v68, 0
    v_mov_b32 v69, 0
    v_mov_b32 v70, 0
    v_mov_b32 v71, 0
    v_mov_b32 v72, 0
    v_mov_b32 v73, 0
    v_mov_b32 v74, 0
    v_mov_b32 v75, 0
    v_mov_b32 v76, 0
    v_mov_b32 v77, 0
    v_mov_b32 v78, 0
    v_mov_b32 v79, 0
    v_mov_b32 v80, 0
    v_mov_b32 v81, 0
    v_mov_b32 v82, 0
    v_mov_b32 v83, 0
    v_mov_b32 v84, 0
    v_mov_b32 v85, 0
    v_mov_b32 v86, 0
    v_mov_b32 v87, 0
    v_mov_b32 v88, 0
    v_mov_b32 v89, 0
    v_mov_b32 v90, 0
    v_mov_b32 v91, 0
    v_mov_b32 v92, 0
    v_mov_b32 v93, 0
    v_mov_b32 v94, 0
    v_mov_b32 v95, 0
    v_mov_b32 v96, 0
    v_mov_b32 v97, 0
    v_mov_b32 v98, 0
    v_mov_b32 v99, 0
    v_mov_b32 v100, 0
    v_mov_b32 v101, 0
    v_mov_b32 v102, 0
    v_mov_b32 v103, 0
    v_mov_b32 v104, 0
    v_mov_b32 v105, 0
    v_mov_b32 v106, 0
    v_mov_b32 v107, 0
    v_mov_b32 v108, 0
    v_mov_b32 v109, 0
    v_mov_b32 v110, 0
    v_mov_b32 v111, 0
    v_mov_b32 v112, 0
    v_mov_b32 v113, 0
    v_mov_b32 v114, 0
    v_mov_b32 v115, 0
    v_mov_b32 v116, 0
    v_mov_b32 v117, 0
    v_mov_b32 v118, 0
    v_mov_b32 v119, 0
    v_mov_b32 v120, 0
    v_mov_b32 v121, 0
    v_mov_b32 v122, 0
    v_mov_b32 v123, 0
    v_mov_b32 v124, 0
    v_mov_b32 v125, 0
    v_mov_b32 v126, 0
    v_mov_b32 v127, 0
    v_mov_b32 v12, 0
    v_mov_b32 v13, 0
    v_mov_b32 v14, 0
    v_mov_b32 v15, 0
    v_mov_b32 v32, 0
    v_mov_b32 v33, 0
    v_mov_b32 v34, 0
    v_mov_b32 v35, 0
    v_mov_b32 v36, 0
    v_mov_b32 v37, 0
    v_mov_b32 v38, 0
    v_mov_b32 v39, 0
    v_mov_b32 v40, 0
    v_mov_b32 v41, 0
    v_mov_b32 v42, 0
    v_mov_b32 v43, 0
    v_mov_b32 v44, 0
    v_mov_b32 v45, 0
    v_mov_b32 v46, 0
    v_mov_b32 v47, 0
    s_mov_b32 s24, 0
L_gc_loop_1021:
    s_barrier
    s_waitcnt lgkmcnt(6)
    v_mfma_f32_32x32x16_bf16 v[64:79], v[12:15], v[32:35], v[64:79]
    ds_read_b128 v[8:11], v1 offset:0
    ds_read_b64_tr_b16 v[16:17], v3 offset:0
    ds_read_b64_tr_b16 v[18:19], v3 offset:1024
    s_waitcnt lgkmcnt(7)
    v_mfma_f32_32x32x16_bf16 v[80:95], v[12:15], v[36:39], v[80:95]
    ds_read_b64_tr_b16 v[20:21], v4 offset:0
    ds_read_b64_tr_b16 v[22:23], v4 offset:1024
    s_waitcnt lgkmcnt(7)
    v_mfma_f32_32x32x16_bf16 v[96:111], v[12:15], v[40:43], v[96:111]
    ds_read_b64_tr_b16 v[24:25], v5 offset:0
    ds_read_b64_tr_b16 v[26:27], v5 offset:1024
    s_waitcnt lgkmcnt(7)
    v_mfma_f32_32x32x16_bf16 v[112:127], v[12:15], v[44:47], v[112:127]
    ds_read_b64_tr_b16 v[28:29], v6 offset:0
    ds_read_b64_tr_b16 v[30:31], v6 offset:1024
    s_waitcnt lgkmcnt(6)
    v_mfma_f32_32x32x16_bf16 v[64:79], v[8:11], v[16:19], v[64:79]
    ds_read_b128 v[12:15], v2 offset:0
    ds_read_b64_tr_b16 v[32:33], v3 offset:4096
    ds_read_b64_tr_b16 v[34:35], v3 offset:5120
    s_waitcnt lgkmcnt(7)
    v_mfma_f32_32x32x16_bf16 v[80:95], v[8:11], v[20:23], v[80:95]
    ds_read_b64_tr_b16 v[36:37], v4 offset:4096
    ds_read_b64_tr_b16 v[38:39], v4 offset:5120
    s_waitcnt lgkmcnt(7)
    v_mfma_f32_32x32x16_bf16 v[96:111], v[8:11], v[24:27], v[96:111]
    ds_read_b64_tr_b16 v[40:41], v5 offset:4096
    ds_read_b64_tr_b16 v[42:43], v5 offset:5120
    s_waitcnt lgkmcnt(7)
    v_mfma_f32_32x32x16_bf16 v[112:127], v[8:11], v[28:31], v[112:127]
    ds_read_b64_tr_b16 v[44:45], v6 offset:4096
    ds_read_b64_tr_b16 v[46:47], v6 offset:5120
    s_barrier
    s_waitcnt lgkmcnt(6)
    v_mfma_f32_32x32x16_bf16 v[64:79], v[12:15], v[32:35], v[64:79]
    ds_read_b128 v[8:11], v1 offset:8192
    ds_read_b64_tr_b16 v[16:17], v3 offset:8192
    ds_read_b64_tr_b16 v[18:19], v3 offset:9216
    s_waitcnt lgkmcnt(7)
    v_mfma_f32_32x32x16_bf16 v[80:95], v[12:15], v[36:39], v[80:95]
    ds_read_b64_tr_b16 v[20:21], v4 offset:8192
    ds_read_b64_tr_b16 v[22:23], v4 offset:9216
    s_waitcnt lgkmcnt(7)
    v_mfma_f32_32x32x16_bf16 v[96:111], v[12:15], v[40:43], v[96:111]
    ds_read_b64_tr_b16 v[24:25], v5 offset:8192
    ds_read_b64_tr_b16 v[26:27], v5 offset:9216
    s_waitcnt lgkmcnt(7)
    v_mfma_f32_32x32x16_bf16 v[112:127], v[12:15], v[44:47], v[112:127]
    ds_read_b64_tr_b16 v[28:29], v6 offset:8192
    ds_read_b64_tr_b16 v[30:31], v6 offset:9216
    s_waitcnt lgkmcnt(6)
    v_mfma_f32_32x32x16_bf16 v[64:79], v[8:11], v[16:19], v[64:79]
    ds_read_b128 v[12:15], v2 offset:8192
    ds_read_b64_tr_b16 v[32:33], v3 offset:12288
    ds_read_b64_tr_b16 v[34:35], v3 offset:13312
    s_waitcnt lgkmcnt(7)
    v_mfma_f32_32x32x16_bf16 v[80:95], v[8:11], v[20:23], v[80:95]
    ds_read_b64_tr_b16 v[36:37], v4 offset:12288
    ds_read_b64_tr_b16 v[38:39], v4 offset:13312
    s_waitcnt lgkmcnt(7)
    v_mfma_f32_32x32x16_bf16 v[96:111], v[8:11], v[24:27], v[96:111]
    ds_read_b64_tr_b16 v[40:41], v5 offset:12288
    ds_read_b64_tr_b16 v[42:43], v5 offset:13312
    s_waitcnt lgkmcnt(7)
    v_mfma_f32_32x32x16_bf16 v[112:127], v[8:11], v[28:31], v[112:127]
    ds_read_b64_tr_b16 v[44:45], v6 offset:12288
    ds_read_b64_tr_b16 v[46:47], v6 offset:13312
    s_barrier
    s_waitcnt lgkmcnt(6)
    v_mfma_f32_32x32x16_bf16 v[64:79], v[12:15], v[32:35], v[64:79]
    ds_read_b128 v[8:11], v1 offset:16384
    ds_read_b64_tr_b16 v[16:17], v3 offset:16384
    ds_read_b64_tr_b16 v[18:19], v3 offset:17408
    s_waitcnt lgkmcnt(7)
    v_mfma_f32_32x32x16_bf16 v[80:95], v[12:15], v[36:39], v[80:95]
    ds_read_b64_tr_b16 v[20:21], v4 offset:16384
    ds_read_b64_tr_b16 v[22:23], v4 offset:17408
    s_waitcnt lgkmcnt(7)
    v_mfma_f32_32x32x16_bf16 v[96:111], v[12:15], v[40:43], v[96:111]
    ds_read_b64_tr_b16 v[24:25], v5 offset:16384
    ds_read_b64_tr_b16 v[26:27], v5 offset:17408
    s_waitcnt lgkmcnt(7)
    v_mfma_f32_32x32x16_bf16 v[112:127], v[12:15], v[44:47], v[112:127]
    ds_read_b64_tr_b16 v[28:29], v6 offset:16384
    ds_read_b64_tr_b16 v[30:31], v6 offset:17408
    s_waitcnt lgkmcnt(6)
    v_mfma_f32_32x32x16_bf16 v[64:79], v[8:11], v[16:19], v[64:79]
    ds_read_b128 v[12:15], v2 offset:16384
    ds_read_b64_tr_b16 v[32:33], v3 offset:20480
    ds_read_b64_tr_b16 v[34:35], v3 offset:21504
    s_waitcnt lgkmcnt(7)
    v_mfma_f32_32x32x16_bf16 v[80:95], v[8:11], v[20:23], v[80:95]
    ds_read_b64_tr_b16 v[36:37], v4 offset:20480
    ds_read_b64_tr_b16 v[38:39], v4 offset:21504
    s_waitcnt lgkmcnt(7)
    v_mfma_f32_32x32x16_bf16 v[96:111], v[8:11], v[24:27], v[96:111]
    ds_read_b64_tr_b16 v[40:41], v5 offset:20480
    ds_read_b64_tr_b16 v[42:43], v5 offset:21504
    s_waitcnt lgkmcnt(7)
    v_mfma_f32_32x32x16_bf16 v[112:127], v[8:11], v[28:31], v[112:127]
    ds_read_b64_tr_b16 v[44:45], v6 offset:20480
    ds_read_b64_tr_b16 v[46:47], v6 offset:21504
    s_barrier
    s_waitcnt lgkmcnt(6)
    v_mfma_f32_32x32x16_bf16 v[64:79], v[12:15], v[32:35], v[64:79]
    ds_read_b128 v[8:11], v1 offset:24576
    ds_read_b64_tr_b16 v[16:17], v3 offset:24576
    ds_read_b64_tr_b16 v[18:19], v3 offset:25600
    s_waitcnt lgkmcnt(7)
    v_mfma_f32_32x32x16_bf16 v[80:95], v[12:15], v[36:39], v[80:95]
    ds_read_b64_tr_b16 v[20:21], v4 offset:24576
    ds_read_b64_tr_b16 v[22:23], v4 offset:25600
    s_waitcnt lgkmcnt(7)
    v_mfma_f32_32x32x16_bf16 v[96:111], v[12:15], v[40:43], v[96:111]
    ds_read_b64_tr_b16 v[24:25], v5 offset:24576
    ds_read_b64_tr_b16 v[26:27], v5 offset:25600
    s_waitcnt lgkmcnt(7)
    v_mfma_f32_32x32x16_bf16 v[112:127], v[12:15], v[44:47], v[112:127]
    ds_read_b64_tr_b16 v[28:29], v6 offset:24576
    ds_read_b64_tr_b16 v[30:31], v6 offset:25600
    s_waitcnt lgkmcnt(6)
    v_mfma_f32_32x32x16_bf16 v[64:79], v[8:11], v[16:19], v[64:79]
    ds_read_b128 v[12:15], v2 offset:24576
    ds_read_b64_tr_b16 v[32:33], v3 offset:28672
    ds_read_b64_tr_b16 v[34:35], v3 offset:29696
    s_waitcnt lgkmcnt(7)
    v_mfma_f32_32x32x16_bf16 v[80:95], v[8:11], v[20:23], v[80:95]
    ds_read_b64_tr_b16 v[36:37], v4 offset:28672
    ds_read_b64_tr_b16 v[38:39], v4 offset:29696
    s_waitcnt lgkmcnt(7)
    v_mfma_f32_32x32x16_bf16 v[96:111], v[8:11], v[24:27], v[96:111]
    ds_read_b64_tr_b16 v[40:41], v5 offset:28672
    ds_read_b64_tr_b16 v[42:43], v5 offset:29696
    s_waitcnt lgkmcnt(7)
    v_mfma_f32_32x32x16_bf16 v[112:127], v[8:11], v[28:31], v[112:127]
    ds_read_b64_tr_b16 v[44:45], v6 offset:28672
    ds_read_b64_tr_b16 v[46:47], v6 offset:29696
    s_barrier
    s_waitcnt lgkmcnt(6)
    v_mfma_f32_32x32x16_bf16 v[64:79], v[12:15], v[32:35], v[64:79]
    ds_read_b128 v[8:11], v1 offset:32768
    ds_read_b64_tr_b16 v[16:17], v3 offset:32768
    ds_read_b64_tr_b16 v[18:19], v3 offset:33792
    s_waitcnt lgkmcnt(7)
    v_mfma_f32_32x32x16_bf16 v[80:95], v[12:15], v[36:39], v[80:95]
    ds_read_b64_tr_b16 v[20:21], v4 offset:32768
    ds_read_b64_tr_b16 v[22:23], v4 offset:33792
    s_waitcnt lgkmcnt(7)
    v_mfma_f32_32x32x16_bf16 v[96:111], v[12:15], v[40:43], v[96:111]
    ds_read_b64_tr_b16 v[24:25], v5 offset:32768
    ds_read_b64_tr_b16 v[26:27], v5 offset:33792
    s_waitcnt lgkmcnt(7)
    v_mfma_f32_32x32x16_bf16 v[112:127], v[12:15], v[44:47], v[112:127]
    ds_read_b64_tr_b16 v[28:29], v6 offset:32768
    ds_read_b64_tr_b16 v[30:31], v6 offset:33792
    s_waitcnt lgkmcnt(6)
    v_mfma_f32_32x32x16_bf16 v[64:79], v[8:11], v[16:19], v[64:79]
    ds_read_b128 v[12:15], v2 offset:32768
    ds_read_b64_tr_b16 v[32:33], v3 offset:36864
    ds_read_b64_tr_b16 v[34:35], v3 offset:37888
    s_waitcnt lgkmcnt(7)
    v_mfma_f32_32x32x16_bf16 v[80:95], v[8:11], v[20:23], v[80:95]
    ds_read_b64_tr_b16 v[36:37], v4 offset:36864
    ds_read_b64_tr_b16 v[38:39], v4 offset:37888
    s_waitcnt lgkmcnt(7)
    v_mfma_f32_32x32x16_bf16 v[96:111], v[8:11], v[24:27], v[96:111]
    ds_read_b64_tr_b16 v[40:41], v5 offset:36864
    ds_read_b64_tr_b16 v[42:43], v5 offset:37888
    s_waitcnt lgkmcnt(7)
    v_mfma_f32_32x32x16_bf16 v[112:127], v[8:11], v[28:31], v[112:127]
    ds_read_b64_tr_b16 v[44:45], v6 offset:36864
    ds_read_b64_tr_b16 v[46:47], v6 offset:37888
    s_add_u32 s24, s24, 5
    s_cmp_lt_u32 s24, 20
    s_cbranch_scc1 L_gc_loop_1021
    s_waitcnt lgkmcnt(0)
    v_mfma_f32_32x32x16_bf16 v[64:79], v[12:15], v[32:35], v[64:79]
    v_mfma_f32_32x32x16_bf16 v[80:95], v[12:15], v[36:39], v[80:95]
    v_mfma_f32_32x32x16_bf16 v[96:111], v[12:15], v[40:43], v[96:111]
    v_mfma_f32_32x32x16_bf16 v[112:127], v[12:15], v[44:47], v[112:127]
    s_sub_u32 s41, s41, 10
    s_lshl_b32 s25, s40, 2
    s_add_u32 s25, s25, s20
    s_mul_i32 s26, s25, 2304
    s_add_u32 s26, s26, 5120
    s_lshl_b32 s27, s41, 7
    v_mov_b32 v60, 0x3f803f80
    v_mov_b32 v61, 0x3f803f80
    v_mov_b32 v62, 0x3f803f80
    v_mov_b32 v63, 0x3f803f80
    v_lshrrev_b32 v54, 5, v0
    v_mul_u32_u24 v54, 320, v54
    s_mov_b32 s28, 147456
    s_nop 7
    v_and_b32 v53, 31, v0
    v_add_u32 v53, s27, v53
    v_mul_u32_u24 v52, 52429, v53
    v_lshrrev_b32 v52, 20, v52
    v_mul_u32_u24 v55, 20, v52
    v_sub_u32 v53, v53, v55
    v_mul_lo_u32 v52, v52, s28
    v_lshlrev_b32 v55, 4, v53
    v_add3_u32 v52, v52, v55, v54
    v_cvt_pk_bf16_f32 v8, v64, v65
    v_cvt_pk_bf16_f32 v9, v66, v67
    v_cvt_pk_bf16_f32 v10, v68, v69
    v_cvt_pk_bf16_f32 v11, v70, v71
    buffer_store_dwordx4 v[8:11], v52, s[16:19], s26 offen offset:0
    v_cvt_pk_bf16_f32 v12, v72, v73
    v_cvt_pk_bf16_f32 v13, v74, v75
    v_cvt_pk_bf16_f32 v14, v76, v77
    v_cvt_pk_bf16_f32 v15, v78, v79
    buffer_store_dwordx4 v[12:15], v52, s[16:19], s26 offen offset:640
    v_and_b32 v53, 31, v0
    v_add_u32 v53, s27, v53
    v_add_u32 v53, 32, v53
    v_mul_u32_u24 v52, 52429, v53
    v_lshrrev_b32 v52, 20, v52
    v_mul_u32_u24 v55, 20, v52
    v_sub_u32 v53, v53, v55
    v_mul_lo_u32 v52, v52, s28
    v_lshlrev_b32 v55, 4, v53
    v_add3_u32 v52, v52, v55, v54
    v_cvt_pk_bf16_f32 v8, v80, v81
    v_cvt_pk_bf16_f32 v9, v82, v83
    v_cvt_pk_bf16_f32 v10, v84, v85
    v_cvt_pk_bf16_f32 v11, v86, v87
    buffer_store_dwordx4 v[8:11], v52, s[16:19], s26 offen offset:0
    v_cvt_pk_bf16_f32 v12, v88, v89
    v_cvt_pk_bf16_f32 v13, v90, v91
    v_cvt_pk_bf16_f32 v14, v92, v93
    v_cvt_pk_bf16_f32 v15, v94, v95
    buffer_store_dwordx4 v[12:15], v52, s[16:19], s26 offen offset:640
    v_and_b32 v53, 31, v0
    v_add_u32 v53, s27, v53
    v_add_u32 v53, 64, v53
    v_mul_u32_u24 v52, 52429, v53
    v_lshrrev_b32 v52, 20, v52
    v_mul_u32_u24 v55, 20, v52
    v_sub_u32 v53, v53, v55
    v_mul_lo_u32 v52, v52, s28
    v_lshlrev_b32 v55, 4, v53
    v_add3_u32 v52, v52, v55, v54
    v_cvt_pk_bf16_f32 v8, v96, v97
    v_cvt_pk_bf16_f32 v9, v98, v99
    v_cvt_pk_bf16_f32 v10, v100, v101
    v_cvt_pk_bf16_f32 v11, v102, v103
    buffer_store_dwordx4 v[8:11], v52, s[16:19], s26 offen offset:0
    v_cvt_pk_bf16_f32 v12, v104, v105
    v_cvt_pk_bf16_f32 v13, v106, v107
    v_cvt_pk_bf16_f32 v14, v108, v109
    v_cvt_pk_bf16_f32 v15, v110, v111
    buffer_store_dwordx4 v[12:15], v52, s[16:19], s26 offen offset:640
    v_and_b32 v53, 31, v0
    v_add_u32 v53, s27, v53
    v_add_u32 v53, 96, v53
    v_mul_u32_u24 v52, 52429, v53
    v_lshrrev_b32 v52, 20, v52
    v_mul_u32_u24 v55, 20, v52
    v_sub_u32 v53, v53, v55
    v_mul_lo_u32 v52, v52, s28
    v_lshlrev_b32 v55, 4, v53
    v_add3_u32 v52, v52, v55, v54
    v_cvt_pk_bf16_f32 v8, v112, v113
    v_cvt_pk_bf16_f32 v9, v114, v115
    v_cvt_pk_bf16_f32 v10, v116, v117
    v_cvt_pk_bf16_f32 v11, v118, v119
    buffer_store_dwordx4 v[8:11], v52, s[16:19], s26 offen offset:0
    v_cvt_pk_bf16_f32 v12, v120, v121
    v_cvt_pk_bf16_f32 v13, v122, v123
    v_cvt_pk_bf16_f32 v14, v124, v125
    v_cvt_pk_bf16_f32 v15, v126, v127
    buffer_store_dwordx4 v[12:15], v52, s[16:19], s26 offen offset:640
L_bq_end_1010:
    s_endpgm
L_done_1001:
    s_endpgm
.globl attn_kernel
.p2align 8
.type attn_kernel,@function
attn_kernel:
    s_cmp_ge_u32 s2, 512
    s_cbranch_scc1 L_done_2001
    s_cmp_ge_u32 s2, 256
    s_cbranch_scc1 L_arole_2002
    s_load_dwordx2 s[8:9], s[0:1], 72
    s_load_dwordx2 s[40:41], s[0:1], 24
    s_load_dwordx2 s[42:43], s[0:1], 48
    s_and_b32 s20, s2, 7
    s_lshr_b32 s21, s2, 3
    s_and_b32 s22, s21, 3
    s_lshl_b32 s12, s20, 2
    s_add_u32 s12, s12, s22
    s_lshr_b32 s13, s21, 2
    v_lshrrev_b32 v4, 6, v0
    v_and_b32 v0, 63, v0
    v_readfirstlane_b32 s14, v4
    s_mov_b32 s98, 1
    v_lshlrev_b32 v3, 4, v0
    s_mul_i32 s26, s12, 147456
    s_add_u32 s26, s26, 4096
    s_lshr_b32 s27, s12, 1
    s_lshl_b32 s27, s27, 15
    s_add_u32 s27, s27, 5242880
    s_waitcnt lgkmcnt(0)
    s_mov_b32 s10, 33554432
    s_mov_b32 s11, 0x00020000
    s_mov_b32 s61, s14
    s_cmp_lt_u32 s14, 4
    s_cbranch_scc1 L_attn_compute_2003
    s_sub_u32 s20, s14, 4
    s_mul_i32 s16, s20, 7168
    s_mul_i32 s21, s20, 4608
    s_add_u32 s15, s26, s21
    s_lshl_b32 s21, s20, 10
    s_add_u32 s48, s27, s21
    s_sub_u32 s48, s48, 3072
    s_mov_b32 s50, 0x000fffff
    s_mov_b32 s51, 0x000fffff
    v_lshrrev_b32 v11, 5, v0
    v_mul_u32_u24 v11, 320, v11
    v_and_b32 v10, 31, v0
    v_lshl_add_u32 v10, v10, 4, v11
    s_mov_b32 s19, 0
    s_add_u32 m0, s19, s16
    s_sub_u32 s21, s15, 384
    buffer_load_dwordx4 v3, s[8:11], s15 offen lds
    s_mov_b64 exec, s[50:51]
    buffer_load_dwordx4 v10, s[8:11], s15 offen offset:1024 lds
    buffer_load_dwordx4 v10, s[8:11], s21 offen offset:2048 lds
    s_mov_b32 exec_lo, -1
    s_mov_b32 exec_hi, 0
    buffer_load_dwordx4 v3, s[8:11], s48 offen offset:3072 lds
    s_mov_b64 exec, -1
    s_add_u32 s15, s15, 2304
    s_add_u32 s48, s48, 512
    s_add_u32 m0, m0, 3584
    s_sub_u32 s21, s15, 384
    buffer_load_dwordx4 v3, s[8:11], s15 offen lds
    s_mov_b64 exec, s[50:51]
    buffer_load_dwordx4 v10, s[8:11], s15 offen offset:1024 lds
    buffer_load_dwordx4 v10, s[8:11], s21 offen offset:2048 lds
    s_mov_b32 exec_lo, -1
    s_mov_b32 exec_hi, 0
    buffer_load_dwordx4 v3, s[8:11], s48 offen offset:3072 lds
    s_mov_b64 exec, -1
    s_add_u32 s15, s15, 16128
    s_add_u32 s48, s48, 3584
    s_lshr_b32 s20, s2, 3
    s_mul_i32 s20, s20, 200
    s_sub_u32 s21, s14, 4
    s_lshl_b32 s21, s21, 6
    s_add_u32 s20, s20, s21
    v_add_u32 v4, s20, v0
    v_lshlrev_b32 v4, 7, v4
    s_mov_b32 s46, 819200
    s_mov_b32 s47, 0x00020000
    s_mov_b32 s19, 28672
    s_mov_b32 s18, 0
    s_waitcnt vmcnt(0)
    s_barrier
L_ld_loop_2004:
    s_cmp_ge_u32 s18, 7
    s_cbranch_scc1 L_ld_skip_2005
    s_add_u32 m0, s19, s16
    s_sub_u32 s21, s15, 384
    buffer_load_dwordx4 v3, s[8:11], s15 offen lds
    s_mov_b64 exec, s[50:51]
    buffer_load_dwordx4 v10, s[8:11], s15 offen offset:1024 lds
    buffer_load_dwordx4 v10, s[8:11], s21 offen offset:2048 lds
    s_mov_b32 exec_lo, -1
    s_mov_b32 exec_hi, 0
    buffer_load_dwordx4 v3, s[8:11], s48 offen offset:3072 lds
    s_mov_b64 exec, -1
    s_add_u32 s15, s15, 2304
    s_add_u32 s48, s48, 512
    s_add_u32 m0, m0, 3584
    s_sub_u32 s21, s15, 384
    buffer_load_dwordx4 v3, s[8:11], s15 offen lds
    s_mov_b64 exec, s[50:51]
    buffer_load_dwordx4 v10, s[8:11], s15 offen offset:1024 lds
    buffer_load_dwordx4 v10, s[8:11], s21 offen offset:2048 lds
    s_mov_b32 exec_lo, -1
    s_mov_b32 exec_hi, 0
    buffer_load_dwordx4 v3, s[8:11], s48 offen offset:3072 lds
    s_mov_b64 exec, -1
    s_add_u32 s15, s15, 16128
    s_add_u32 s48, s48, 3584
    s_sub_u32 s21, s18, 1
    s_cmp_gt_u32 s21, 1
    s_cbranch_scc1 L_wopf_skip_2006
    s_cmp_eq_u32 s18, 1
    s_cselect_b32 s44, s40, s42
    s_cselect_b32 s45, s41, s43
    buffer_load_dword v5, v4, s[44:47], 0 offen
L_wopf_skip_2006:
    s_sub_u32 s19, 28672, s19
    s_waitcnt vmcnt(0)
L_ld_skip_2005:
    s_barrier
    s_add_u32 s18, s18, 1
    s_cmp_lt_u32 s18, 8
    s_cbranch_scc1 L_ld_loop_2004
    s_bitcmp1_b32 s2, 3
    s_cbranch_scc1 L_ld_exit_2007
    s_and_b32 s20, s14, 3
    s_mov_b32 s42, 1
L_out_loader_shared:
    s_load_dwordx2 s[8:9], s[0:1], 72
    s_load_dwordx2 s[16:17], s[0:1], 56
    s_load_dwordx2 s[12:13], s[0:1], 24
    s_load_dwordx2 s[46:47], s[0:1], 48
    s_load_dwordx2 s[62:63], s[0:1], 72
    s_and_b32 s25, s2, 7
    s_lshr_b32 s26, s2, 4
    s_lshl_b32 s40, s25, 1
    s_lshr_b32 s27, s26, 3
    s_add_u32 s40, s40, s27
    s_and_b32 s41, s26, 7
    s_mul_i32 s28, s40, 196608
    s_mul_i32 s29, s42, -3145728
    s_add_u32 s28, s28, s29
    s_add_u32 s28, s28, 20971520
    s_waitcnt lgkmcnt(0)
    s_cmp_eq_u32 s42, 0
    s_cselect_b32 s12, s12, s46
    s_cselect_b32 s13, s13, s47
    s_add_u32 s8, s8, s28
    s_addc_u32 s9, s9, 0
    s_mov_b32 s10, 196608
    s_mov_b32 s11, 0x00020000
    s_mov_b32 s14, 819200
    s_mov_b32 s15, 0x00020000
    s_mov_b32 s18, 5242880
    s_mov_b32 s19, 0x00020000
    s_mov_b32 s64, s62
    s_mov_b32 s65, s63
    s_mov_b32 s66, 33554432
    s_mov_b32 s67, 0x00020000
    v_lshlrev_b32 v18, 4, v0
    s_lshl_b32 s25, s20, 7
    v_add_u32 v3, s25, v0
    v_mul_u32_u24 v4, 43691, v3
    v_lshrrev_b32 v4, 19, v4
    v_mul_u32_u24 v5, 12, v4
    v_sub_u32 v5, v3, v5
    v_lshlrev_b32 v5, 4, v5
    v_mul_u32_u24 v6, 1280, v4
    v_add_u32 v6, v6, v5
    v_cmp_le_u32 vcc, 40, v4
    v_mov_b32 v5, 0x7ff00000
    s_nop 0
    v_cndmask_b32 v16, v6, v5, vcc
    s_lshl_b32 s25, s20, 7
    s_add_u32 s25, s25, 64
    v_add_u32 v3, s25, v0
    v_mul_u32_u24 v4, 43691, v3
    v_lshrrev_b32 v4, 19, v4
    v_mul_u32_u24 v5, 12, v4
    v_sub_u32 v5, v3, v5
    v_lshlrev_b32 v5, 4, v5
    v_mul_u32_u24 v6, 1280, v4
    v_add_u32 v6, v6, v5
    v_cmp_le_u32 vcc, 40, v4
    v_mov_b32 v5, 0x7ff00000
    s_nop 0
    v_cndmask_b32 v17, v6, v5, vcc
    s_lshl_b32 s58, s41, 1
    s_mul_i32 s21, s58, 12288
    s_mul_i32 s25, s20, 3072
    s_add_u32 s21, s21, s25
    s_mov_b32 s27, s25
    s_lshl_b32 s28, s20, 11
    s_mov_b32 s60, s58
    s_mul_i32 s22, s58, 51200
    s_mul_i32 s25, s41, 160
    s_and_b32 s25, s25, -64
    s_add_u32 s22, s22, s25
    s_mov_b32 s68, -184320
    s_mov_b32 s69, -768000
    s_mov_b32 s63, 51200
    s_barrier
    s_add_u32 m0, s28, 49152
    s_add_u32 s60, s60, 1
    buffer_load_dwordx4 v16, s[12:15], s22 offen lds
    s_add_u32 m0, s28, 50176
    s_cmp_eq_u32 s60, 16
    buffer_load_dwordx4 v17, s[12:15], s22 offen lds
    s_cselect_b32 s29, s69, s63
    s_add_u32 s22, s22, s29
    s_add_u32 m0, s28, 57344
    s_add_u32 s60, s60, 1
    buffer_load_dwordx4 v16, s[12:15], s22 offen lds
    s_add_u32 m0, s28, 58368
    s_cmp_eq_u32 s60, 16
    buffer_load_dwordx4 v17, s[12:15], s22 offen lds
    s_cselect_b32 s29, s69, s63
    s_add_u32 s22, s22, s29
    s_add_u32 m0, s28, 65536
    s_add_u32 s60, s60, 1
    buffer_load_dwordx4 v16, s[12:15], s22 offen lds
    s_add_u32 m0, s28, 66560
    s_cmp_eq_u32 s60, 16
    buffer_load_dwordx4 v17, s[12:15], s22 offen lds
    s_cselect_b32 s29, s69, s63
    s_add_u32 s22, s22, s29
    s_cmp_lg_u32 s20, 0
    s_cbranch_scc1 L_op_nopoll_2008
    s_lshr_b32 s25, s40, s42
    s_lshl_b32 s25, s25, 7
    s_mov_b32 s30, 15208448
    s_cmp_eq_u32 s42, 0
    s_cselect_b32 s30, s30, 15206400
    s_cselect_b32 s49, 0xffff, -1
    s_add_u32 s25, s25, s30
    s_mov_b32 exec_lo, s49
    s_mov_b32 exec_hi, 0
    v_lshlrev_b32 v3, 2, v0
    s_mov_b32 s26, 0
    buffer_load_dword v4, v3, s[64:67], s25 offen sc1
    s_sleep 6
    buffer_load_dword v5, v3, s[64:67], s25 offen sc1
    s_sleep 6
L_op_poll_2009:
    buffer_load_dword v6, v3, s[64:67], s25 offen sc1
    s_waitcnt vmcnt(2)
    v_cmp_eq_u32 vcc, s98, v4
    s_nop 1
    s_cmp_eq_u32 vcc_lo, s49
    s_cbranch_scc1 L_op_poll_done_2010
    s_sleep 4
    buffer_load_dword v4, v3, s[64:67], s25 offen sc1
    s_waitcnt vmcnt(2)
    v_cmp_eq_u32 vcc, s98, v5
    s_nop 1
    s_cmp_eq_u32 vcc_lo, s49
    s_cbranch_scc1 L_op_poll_done_2010
    s_sleep 4
    buffer_load_dword v5, v3, s[64:67], s25 offen sc1
    s_waitcnt vmcnt(2)
    v_cmp_eq_u32 vcc, s98, v6
    s_nop 1
    s_cmp_eq_u32 vcc_lo, s49
    s_cbranch_scc1 L_op_poll_done_2010
    s_sleep 4
    s_add_u32 s26, s26, 1
    s_cmp_lt_u32 s26, 0x20000
    s_cbranch_scc1 L_op_poll_2009
L_op_poll_done_2010:
    s_waitcnt vmcnt(0)
    s_mov_b64 exec, -1
L_op_nopoll_2008:
    s_barrier
    s_add_u32 m0, s27, 0
    s_add_u32 s58, s58, 1
    buffer_load_dwordx4 v18, s[8:11], s21 offen offset:0 sc1 lds
    buffer_load_dwordx4 v18, s[8:11], s21 offen offset:1024 sc1 lds
    buffer_load_dwordx4 v18, s[8:11], s21 offen offset:2048 sc1 lds
    s_cmp_eq_u32 s58, 16
    s_cselect_b32 s29, s68, 12288
    s_add_u32 s21, s21, s29
    s_add_u32 m0, s27, 12288
    s_add_u32 s58, s58, 1
    buffer_load_dwordx4 v18, s[8:11], s21 offen offset:0 sc1 lds
    buffer_load_dwordx4 v18, s[8:11], s21 offen offset:1024 sc1 lds
    buffer_load_dwordx4 v18, s[8:11], s21 offen offset:2048 sc1 lds
    s_cmp_eq_u32 s58, 16
    s_cselect_b32 s29, s68, 12288
    s_add_u32 s21, s21, s29
    s_add_u32 m0, s27, 24576
    s_add_u32 s58, s58, 1
    buffer_load_dwordx4 v18, s[8:11], s21 offen offset:0 sc1 lds
    buffer_load_dwordx4 v18, s[8:11], s21 offen offset:1024 sc1 lds
    buffer_load_dwordx4 v18, s[8:11], s21 offen offset:2048 sc1 lds
    s_cmp_eq_u32 s58, 16
    s_cselect_b32 s29, s68, 12288
    s_add_u32 s21, s21, s29
    s_waitcnt vmcnt(6)
    s_barrier
    s_add_u32 m0, s28, 73728
    s_add_u32 s60, s60, 1
    buffer_load_dwordx4 v16, s[12:15], s22 offen lds
    s_add_u32 m0, s28, 74752
    s_cmp_eq_u32 s60, 16
    buffer_load_dwordx4 v17, s[12:15], s22 offen lds
    s_cselect_b32 s29, s69, s63
    s_add_u32 s22, s22, s29
    s_add_u32 m0, s27, 36864
    s_add_u32 s58, s58, 1
    buffer_load_dwordx4 v18, s[8:11], s21 offen offset:0 sc1 lds
    buffer_load_dwordx4 v18, s[8:11], s21 offen offset:1024 sc1 lds
    buffer_load_dwordx4 v18, s[8:11], s21 offen offset:2048 sc1 lds
    s_cmp_eq_u32 s58, 16
    s_cselect_b32 s29, s68, 12288
    s_add_u32 s21, s21, s29
    s_waitcnt vmcnt(8)
    s_barrier
    s_add_u32 m0, s28, 49152
    s_add_u32 s60, s60, 1
    buffer_load_dwordx4 v16, s[12:15], s22 offen lds
    s_add_u32 m0, s28, 50176
    s_cmp_eq_u32 s60, 16
    buffer_load_dwordx4 v17, s[12:15], s22 offen lds
    s_cselect_b32 s29, s69, s63
    s_add_u32 s22, s22, s29
    s_add_u32 m0, s27, 0
    s_add_u32 s58, s58, 1
    buffer_load_dwordx4 v18, s[8:11], s21 offen offset:0 sc1 lds
    buffer_load_dwordx4 v18, s[8:11], s21 offen offset:1024 sc1 lds
    buffer_load_dwordx4 v18, s[8:11], s21 offen offset:2048 sc1 lds
    s_cmp_eq_u32 s58, 16
    s_cselect_b32 s29, s68, 12288
    s_add_u32 s21, s21, s29
    s_waitcnt vmcnt(10)
    s_barrier
    s_add_u32 m0, s28, 57344
    s_add_u32 s60, s60, 1
    buffer_load_dwordx4 v16, s[12:15], s22 offen lds
    s_add_u32 m0, s28, 58368
    s_cmp_eq_u32 s60, 16
    buffer_load_dwordx4 v17, s[12:15], s22 offen lds
    s_cselect_b32 s29, s69, s63
    s_add_u32 s22, s22, s29
    s_add_u32 m0, s27, 12288
    s_add_u32 s58, s58, 1
    buffer_load_dwordx4 v18, s[8:11], s21 offen offset:0 sc1 lds
    buffer_load_dwordx4 v18, s[8:11], s21 offen offset:1024 sc1 lds
    buffer_load_dwordx4 v18, s[8:11], s21 offen offset:2048 sc1 lds
    s_cmp_eq_u32 s58, 16
    s_cselect_b32 s29, s68, 12288
    s_add_u32 s21, s21, s29
    s_waitcnt vmcnt(10)
    s_barrier
    s_add_u32 m0, s28, 65536
    s_add_u32 s60, s60, 1
    buffer_load_dwordx4 v16, s[12:15], s22 offen lds
    s_add_u32 m0, s28, 66560
    s_cmp_eq_u32 s60, 16
    buffer_load_dwordx4 v17, s[12:15], s22 offen lds
    s_cselect_b32 s29, s69, s63
    s_add_u32 s22, s22, s29
    s_add_u32 m0, s27, 24576
    s_add_u32 s58, s58, 1
    buffer_load_dwordx4 v18, s[8:11], s21 offen offset:0 sc1 lds
    buffer_load_dwordx4 v18, s[8:11], s21 offen offset:1024 sc1 lds
    buffer_load_dwordx4 v18, s[8:11], s21 offen offset:2048 sc1 lds
    s_cmp_eq_u32 s58, 16
    s_cselect_b32 s29, s68, 12288
    s_add_u32 s21, s21, s29
    s_waitcnt vmcnt(10)
    s_barrier
    s_add_u32 m0, s28, 73728
    s_add_u32 s60, s60, 1
    buffer_load_dwordx4 v16, s[12:15], s22 offen lds
    s_add_u32 m0, s28, 74752
    s_cmp_eq_u32 s60, 16
    buffer_load_dwordx4 v17, s[12:15], s22 offen lds
    s_cselect_b32 s29, s69, s63
    s_add_u32 s22, s22, s29
    s_add_u32 m0, s27, 36864
    s_add_u32 s58, s58, 1
    buffer_load_dwordx4 v18, s[8:11], s21 offen offset:0 sc1 lds
    buffer_load_dwordx4 v18, s[8:11], s21 offen offset:1024 sc1 lds
    buffer_load_dwordx4 v18, s[8:11], s21 offen offset:2048 sc1 lds
    s_cmp_eq_u32 s58, 16
    s_cselect_b32 s29, s68, 12288
    s_add_u32 s21, s21, s29
    s_waitcnt vmcnt(10)
    s_barrier
    s_add_u32 m0, s28, 49152
    s_add_u32 s60, s60, 1
    buffer_load_dwordx4 v16, s[12:15], s22 offen lds
    s_add_u32 m0, s28, 50176
    s_cmp_eq_u32 s60, 16
    buffer_load_dwordx4 v17, s[12:15], s22 offen lds
    s_cselect_b32 s29, s69, s63
    s_add_u32 s22, s22, s29
    s_add_u32 m0, s27, 0
    s_add_u32 s58, s58, 1
    buffer_load_dwordx4 v18, s[8:11], s21 offen offset:0 sc1 lds
    buffer_load_dwordx4 v18, s[8:11], s21 offen offset:1024 sc1 lds
    buffer_load_dwordx4 v18, s[8:11], s21 offen offset:2048 sc1 lds
    s_cmp_eq_u32 s58, 16
    s_cselect_b32 s29, s68, 12288
    s_add_u32 s21, s21, s29
    s_waitcnt vmcnt(10)
    s_barrier
    s_add_u32 m0, s28, 57344
    s_add_u32 s60, s60, 1
    buffer_load_dwordx4 v16, s[12:15], s22 offen lds
    s_add_u32 m0, s28, 58368
    s_cmp_eq_u32 s60, 16
    buffer_load_dwordx4 v17, s[12:15], s22 offen lds
    s_cselect_b32 s29, s69, s63
    s_add_u32 s22, s22, s29
    s_add_u32 m0, s27, 12288
    s_add_u32 s58, s58, 1
    buffer_load_dwordx4 v18, s[8:11], s21 offen offset:0 sc1 lds
    buffer_load_dwordx4 v18, s[8:11], s21 offen offset:1024 sc1 lds
    buffer_load_dwordx4 v18, s[8:11], s21 offen offset:2048 sc1 lds
    s_cmp_eq_u32 s58, 16
    s_cselect_b32 s29, s68, 12288
    s_add_u32 s21, s21, s29
    s_waitcnt vmcnt(10)
    s_barrier
    s_add_u32 m0, s28, 65536
    s_add_u32 s60, s60, 1
    buffer_load_dwordx4 v16, s[12:15], s22 offen lds
    s_add_u32 m0, s28, 66560
    s_cmp_eq_u32 s60, 16
    buffer_load_dwordx4 v17, s[12:15], s22 offen lds
    s_cselect_b32 s29, s69, s63
    s_add_u32 s22, s22, s29
    s_add_u32 m0, s27, 24576
    s_add_u32 s58, s58, 1
    buffer_load_dwordx4 v18, s[8:11], s21 offen offset:0 sc1 lds
    buffer_load_dwordx4 v18, s[8:11], s21 offen offset:1024 sc1 lds
    buffer_load_dwordx4 v18, s[8:11], s21 offen offset:2048 sc1 lds
    s_cmp_eq_u32 s58, 16
    s_cselect_b32 s29, s68, 12288
    s_add_u32 s21, s21, s29
    s_waitcnt vmcnt(10)
    s_barrier
    s_add_u32 m0, s28, 73728
    s_add_u32 s60, s60, 1
    buffer_load_dwordx4 v16, s[12:15], s22 offen lds
    s_add_u32 m0, s28, 74752
    s_cmp_eq_u32 s60, 16
    buffer_load_dwordx4 v17, s[12:15], s22 offen lds
    s_cselect_b32 s29, s69, s63
    s_add_u32 s22, s22, s29
    s_add_u32 m0, s27, 36864
    s_add_u32 s58, s58, 1
    buffer_load_dwordx4 v18, s[8:11], s21 offen offset:0 sc1 lds
    buffer_load_dwordx4 v18, s[8:11], s21 offen offset:1024 sc1 lds
    buffer_load_dwordx4 v18, s[8:11], s21 offen offset:2048 sc1 lds
    s_cmp_eq_u32 s58, 16
    s_cselect_b32 s29, s68, 12288
    s_add_u32 s21, s21, s29
    s_waitcnt vmcnt(10)
    s_barrier
    s_add_u32 m0, s28, 49152
    s_add_u32 s60, s60, 1
    buffer_load_dwordx4 v16, s[12:15], s22 offen lds
    s_add_u32 m0, s28, 50176
    s_cmp_eq_u32 s60, 16
    buffer_load_dwordx4 v17, s[12:15], s22 offen lds
    s_cselect_b32 s29, s69, s63
    s_add_u32 s22, s22, s29
    s_add_u32 m0, s27, 0
    s_add_u32 s58, s58, 1
    buffer_load_dwordx4 v18, s[8:11], s21 offen offset:0 sc1 lds
    buffer_load_dwordx4 v18, s[8:11], s21 offen offset:1024 sc1 lds
    buffer_load_dwordx4 v18, s[8:11], s21 offen offset:2048 sc1 lds
    s_cmp_eq_u32 s58, 16
    s_cselect_b32 s29, s68, 12288
    s_add_u32 s21, s21, s29
    s_waitcnt vmcnt(10)
    s_barrier
    s_add_u32 m0, s28, 57344
    s_add_u32 s60, s60, 1
    buffer_load_dwordx4 v16, s[12:15], s22 offen lds
    s_add_u32 m0, s28, 58368
    s_cmp_eq_u32 s60, 16
    buffer_load_dwordx4 v17, s[12:15], s22 offen lds
    s_cselect_b32 s29, s69, s63
    s_add_u32 s22, s22, s29
    s_add_u32 m0, s27, 12288
    s_add_u32 s58, s58, 1
    buffer_load_dwordx4 v18, s[8:11], s21 offen offset:0 sc1 lds
    buffer_load_dwordx4 v18, s[8:11], s21 offen offset:1024 sc1 lds
    buffer_load_dwordx4 v18, s[8:11], s21 offen offset:2048 sc1 lds
    s_cmp_eq_u32 s58, 16
    s_cselect_b32 s29, s68, 12288
    s_add_u32 s21, s21, s29
    s_waitcnt vmcnt(10)
    s_barrier
    s_add_u32 m0, s28, 65536
    s_add_u32 s60, s60, 1
    buffer_load_dwordx4 v16, s[12:15], s22 offen lds
    s_add_u32 m0, s28, 66560
    s_cmp_eq_u32 s60, 16
    buffer_load_dwordx4 v17, s[12:15], s22 offen lds
    s_cselect_b32 s29, s69, s63
    s_add_u32 s22, s22, s29
    s_add_u32 m0, s27, 24576
    s_add_u32 s58, s58, 1
    buffer_load_dwordx4 v18, s[8:11], s21 offen offset:0 sc1 lds
    buffer_load_dwordx4 v18, s[8:11], s21 offen offset:1024 sc1 lds
    buffer_load_dwordx4 v18, s[8:11], s21 offen offset:2048 sc1 lds
    s_cmp_eq_u32 s58, 16
    s_cselect_b32 s29, s68, 12288
    s_add_u32 s21, s21, s29
    s_waitcnt vmcnt(10)
    s_barrier
    s_add_u32 m0, s28, 73728
    s_add_u32 s60, s60, 1
    buffer_load_dwordx4 v16, s[12:15], s22 offen lds
    s_add_u32 m0, s28, 74752
    s_cmp_eq_u32 s60, 16
    buffer_load_dwordx4 v17, s[12:15], s22 offen lds
    s_cselect_b32 s29, s69, s63
    s_add_u32 s22, s22, s29
    s_add_u32 m0, s27, 36864
    s_add_u32 s58, s58, 1
    buffer_load_dwordx4 v18, s[8:11], s21 offen offset:0 sc1 lds
    buffer_load_dwordx4 v18, s[8:11], s21 offen offset:1024 sc1 lds
    buffer_load_dwordx4 v18, s[8:11], s21 offen offset:2048 sc1 lds
    s_cmp_eq_u32 s58, 16
    s_cselect_b32 s29, s68, 12288
    s_add_u32 s21, s21, s29
    s_waitcnt vmcnt(10)
    s_barrier
    s_waitcnt vmcnt(5)
    s_barrier
    s_waitcnt vmcnt(0)
    s_barrier
    s_endpgm
L_ld_exit_2007:
    s_endpgm
L_attn_compute_2003:
    s_setprio 2
    v_mov_b32 v1, v3
    v_lshlrev_b32 v2, 3, v0
    s_lshl_b32 s20, s13, 3
    s_lshl_b32 s21, s14, 1
    s_add_u32 s20, s20, s21
    s_lshl_b32 s21, s12, 6
    s_add_u32 s21, s21, s20
    s_lshl_b32 s21, s21, 10
    s_add_u32 s21, s21, 7340032
    buffer_load_dwordx4 v[84:87], v3, s[8:11], s21 offen
    buffer_load_dwordx4 v[88:91], v3, s[8:11], s21 offen offset:1024
    s_lshr_b32 s22, s12, 1
    s_lshl_b32 s22, s22, 6
    s_add_u32 s22, s22, s20
    s_lshl_b32 s22, s22, 9
    s_add_u32 s22, s22, 9437184
    buffer_load_dwordx2 v[92:93], v2, s[8:11], s22 offen
    buffer_load_dwordx2 v[94:95], v2, s[8:11], s22 offen offset:512
    s_add_u32 s23, s26, 145152
    buffer_load_dwordx4 v[100:103], v3, s[8:11], s23 offen
    s_add_u32 s23, s27, 32256
    buffer_load_dwordx2 v[122:123], v2, s[8:11], s23 offen
    v_and_b32 v4, 27, v0
    v_and_b32 v4, 31, v0
    v_and_b32 v5, 27, v4
    v_cmp_eq_u32 s[22:23], 20, v4
    v_cmp_eq_u32 s[24:25], 24, v4
    v_mov_b32 v6, 0x3f803f80
    s_nop 0
    s_or_b64 vcc, s[22:23], s[24:25]
    s_nop 1
    v_cndmask_b32 v8, 0, v6, vcc
    v_cndmask_b32 v9, 0, v6, vcc
    v_cndmask_b32 v10, 0, v6, vcc
    v_cndmask_b32 v11, 0, v6, vcc
    s_mul_i32 s23, s14, 14336
    v_add_u32 v7, s23, v3
    s_mov_b32 exec_lo, 0xfff00000
    s_mov_b32 exec_hi, 0xfff00000
    ds_write_b128 v7, v[8:11] offset:1024
    ds_write_b128 v7, v[8:11] offset:2048
    ds_write_b128 v7, v[8:11] offset:4608
    ds_write_b128 v7, v[8:11] offset:5632
    ds_write_b128 v7, v[8:11] offset:8192
    ds_write_b128 v7, v[8:11] offset:9216
    ds_write_b128 v7, v[8:11] offset:11776
    ds_write_b128 v7, v[8:11] offset:12800
    s_mov_b64 exec, -1
    v_mov_b32 v36, 0
    v_mov_b32 v37, 0
    v_mov_b32 v38, 0
    v_mov_b32 v39, 0
    v_mov_b32 v40, 0
    v_mov_b32 v41, 0
    v_mov_b32 v42, 0
    v_mov_b32 v43, 0
    v_mov_b32 v44, 0
    v_mov_b32 v45, 0
    v_mov_b32 v46, 0
    v_mov_b32 v47, 0
    v_mov_b32 v48, 0
    v_mov_b32 v49, 0
    v_mov_b32 v50, 0
    v_mov_b32 v51, 0
    v_mov_b32 v52, 0
    v_mov_b32 v53, 0
    v_mov_b32 v54, 0
    v_mov_b32 v55, 0
    v_mov_b32 v56, 0
    v_mov_b32 v57, 0
    v_mov_b32 v58, 0
    v_mov_b32 v59, 0
    v_mov_b32 v60, 0
    v_mov_b32 v61, 0
    v_mov_b32 v62, 0
    v_mov_b32 v63, 0
    v_mov_b32 v64, 0
    v_mov_b32 v65, 0
    v_mov_b32 v66, 0
    v_mov_b32 v67, 0
    v_mov_b32 v76, 0
    v_mov_b32 v77, 0
    v_mov_b32 v78, 0
    v_mov_b32 v79, 0
    v_mov_b32 v80, 0
    v_mov_b32 v81, 0
    v_mov_b32 v82, 0
    v_mov_b32 v83, 0
    v_mov_b32 v32, 0
    v_mov_b32 v33, 0
    v_mov_b32 v34, 0
    v_mov_b32 v35, 0
    v_mov_b32 v112, 0
    v_mov_b32 v113, 0
    v_mov_b32 v114, 0
    v_mov_b32 v115, 0
    v_mov_b32 v116, 0
    v_mov_b32 v117, 0
    v_mov_b32 v118, 0
    v_mov_b32 v119, 0
    v_mov_b32 v104, 0
    v_mov_b32 v105, 0
    v_mov_b32 v106, 0
    v_mov_b32 v107, 0
    v_mov_b32 v108, 0
    v_mov_b32 v109, 0
    v_mov_b32 v110, 0
    v_mov_b32 v111, 0
    s_and_b32 s23, s12, 1
    s_cmp_eq_u32 s23, 0
    s_cselect_b32 s24, 0, -1
    s_cselect_b32 s25, -1, 0
    s_mov_b32 s17, 28672
    s_mov_b32 s34, 0x011fffff
    s_mov_b32 s35, 0x011fffff
    s_waitcnt vmcnt(0)
    s_mov_b64 exec, s[24:25]
    v_mov_b32 v92, 0
    v_mov_b32 v93, 0
    v_mov_b32 v94, 0
    v_mov_b32 v95, 0
    s_mov_b64 exec, -1
    s_nop 1
    s_waitcnt lgkmcnt(0)
    v_mfma_f32_32x32x16_bf16 v[4:19], v[100:103], v[84:87], 0
    v_mfma_f32_32x32x8_bf16 v[4:19], v[122:123], v[92:93], v[4:19]
    s_mov_b32 s18, 0
    s_barrier
    ds_read_b128 v[96:99], v1 offset:0
    ds_read_b64 v[120:121], v2 offset:3072
    ds_read_b128 v[104:107], v1 offset:1024
    ds_read_b128 v[108:111], v1 offset:2048
    s_nop 7
.p2align 6
L_attn_loop_2011:
    v_mfma_f32_32x32x16_bf16 v[52:67], v[112:115], v[76:79], v[52:67]
    v_exp_f32 v4, v4
    v_exp_f32 v5, v5
    v_exp_f32 v6, v6
    v_exp_f32 v7, v7
    v_cvt_pk_bf16_f32 v82, v32, v33
    v_cvt_pk_bf16_f32 v83, v34, v35
    v_mfma_f32_32x32x16_bf16 v[20:35], v[100:103], v[88:91], 0
    v_exp_f32 v8, v8
    v_exp_f32 v9, v9
    v_exp_f32 v10, v10
    v_exp_f32 v11, v11
    v_cvt_pk_bf16_f32 v68, v4, v5
    v_cvt_pk_bf16_f32 v69, v6, v7
    v_mfma_f32_32x32x8_bf16 v[20:35], v[122:123], v[94:95], v[20:35]
    v_exp_f32 v12, v12
    v_exp_f32 v13, v13
    v_exp_f32 v14, v14
    v_exp_f32 v15, v15
    v_cvt_pk_bf16_f32 v70, v8, v9
    v_cvt_pk_bf16_f32 v71, v10, v11
    v_mfma_f32_32x32x16_bf16 v[52:67], v[116:119], v[80:83], v[52:67]
    v_exp_f32 v16, v16
    v_exp_f32 v17, v17
    v_exp_f32 v18, v18
    v_exp_f32 v19, v19
    v_cvt_pk_bf16_f32 v72, v12, v13
    v_cvt_pk_bf16_f32 v73, v14, v15
    s_waitcnt lgkmcnt(0)
    v_mfma_f32_32x32x16_bf16 v[36:51], v[104:107], v[68:71], v[36:51]
    ds_read_b128 v[100:103], v1 offset:3584
    ds_read_b64 v[122:123], v2 offset:6656
    v_exp_f32 v20, v20
    v_exp_f32 v21, v21
    v_exp_f32 v22, v22
    v_exp_f32 v23, v23
    v_cvt_pk_bf16_f32 v74, v16, v17
    v_cvt_pk_bf16_f32 v75, v18, v19
    v_mfma_f32_32x32x16_bf16 v[4:19], v[96:99], v[84:87], 0
    ds_read_b128 v[112:115], v1 offset:4608
    ds_read_b128 v[116:119], v1 offset:5632
    v_exp_f32 v24, v24
    v_exp_f32 v25, v25
    v_exp_f32 v26, v26
    v_exp_f32 v27, v27
    v_cvt_pk_bf16_f32 v76, v20, v21
    v_cvt_pk_bf16_f32 v77, v22, v23
    v_mfma_f32_32x32x8_bf16 v[4:19], v[120:121], v[92:93], v[4:19]
    v_exp_f32 v28, v28
    v_exp_f32 v29, v29
    v_exp_f32 v30, v30
    v_exp_f32 v31, v31
    v_cvt_pk_bf16_f32 v78, v24, v25
    v_cvt_pk_bf16_f32 v79, v26, v27
    v_mfma_f32_32x32x16_bf16 v[36:51], v[108:111], v[72:75], v[36:51]
    v_exp_f32 v32, v32
    v_exp_f32 v33, v33
    v_exp_f32 v34, v34
    v_exp_f32 v35, v35
    v_cvt_pk_bf16_f32 v80, v28, v29
    v_cvt_pk_bf16_f32 v81, v30, v31
    v_mfma_f32_32x32x16_bf16 v[52:67], v[104:107], v[76:79], v[52:67]
    v_exp_f32 v4, v4
    v_exp_f32 v5, v5
    v_exp_f32 v6, v6
    v_exp_f32 v7, v7
    v_cvt_pk_bf16_f32 v82, v32, v33
    v_cvt_pk_bf16_f32 v83, v34, v35
    v_mfma_f32_32x32x16_bf16 v[20:35], v[96:99], v[88:91], 0
    v_exp_f32 v8, v8
    v_exp_f32 v9, v9
    v_exp_f32 v10, v10
    v_exp_f32 v11, v11
    v_cvt_pk_bf16_f32 v68, v4, v5
    v_cvt_pk_bf16_f32 v69, v6, v7
    v_mfma_f32_32x32x8_bf16 v[20:35], v[120:121], v[94:95], v[20:35]
    v_exp_f32 v12, v12
    v_exp_f32 v13, v13
    v_exp_f32 v14, v14
    v_exp_f32 v15, v15
    v_cvt_pk_bf16_f32 v70, v8, v9
    v_cvt_pk_bf16_f32 v71, v10, v11
    v_mfma_f32_32x32x16_bf16 v[52:67], v[108:111], v[80:83], v[52:67]
    v_exp_f32 v16, v16
    v_exp_f32 v17, v17
    v_exp_f32 v18, v18
    v_exp_f32 v19, v19
    v_cvt_pk_bf16_f32 v72, v12, v13
    v_cvt_pk_bf16_f32 v73, v14, v15
    s_waitcnt lgkmcnt(0)
    v_mfma_f32_32x32x16_bf16 v[36:51], v[112:115], v[68:71], v[36:51]
    ds_read_b128 v[96:99], v1 offset:7168
    ds_read_b64 v[120:121], v2 offset:10240
    v_exp_f32 v20, v20
    v_exp_f32 v21, v21
    v_exp_f32 v22, v22
    v_exp_f32 v23, v23
    v_cvt_pk_bf16_f32 v74, v16, v17
    v_cvt_pk_bf16_f32 v75, v18, v19
    v_mfma_f32_32x32x16_bf16 v[4:19], v[100:103], v[84:87], 0
    ds_read_b128 v[104:107], v1 offset:8192
    ds_read_b128 v[108:111], v1 offset:9216
    v_exp_f32 v24, v24
    v_exp_f32 v25, v25
    v_exp_f32 v26, v26
    v_exp_f32 v27, v27
    v_cvt_pk_bf16_f32 v76, v20, v21
    v_cvt_pk_bf16_f32 v77, v22, v23
    v_mfma_f32_32x32x8_bf16 v[4:19], v[122:123], v[92:93], v[4:19]
    v_exp_f32 v28, v28
    v_exp_f32 v29, v29
    v_exp_f32 v30, v30
    v_exp_f32 v31, v31
    v_cvt_pk_bf16_f32 v78, v24, v25
    v_cvt_pk_bf16_f32 v79, v26, v27
    v_mfma_f32_32x32x16_bf16 v[36:51], v[116:119], v[72:75], v[36:51]
    v_exp_f32 v32, v32
    v_exp_f32 v33, v33
    v_exp_f32 v34, v34
    v_exp_f32 v35, v35
    v_cvt_pk_bf16_f32 v80, v28, v29
    v_cvt_pk_bf16_f32 v81, v30, v31
    v_mfma_f32_32x32x16_bf16 v[52:67], v[112:115], v[76:79], v[52:67]
    v_exp_f32 v4, v4
    v_exp_f32 v5, v5
    v_exp_f32 v6, v6
    v_exp_f32 v7, v7
    v_cvt_pk_bf16_f32 v82, v32, v33
    v_cvt_pk_bf16_f32 v83, v34, v35
    v_mfma_f32_32x32x16_bf16 v[20:35], v[100:103], v[88:91], 0
    v_exp_f32 v8, v8
    v_exp_f32 v9, v9
    v_exp_f32 v10, v10
    v_exp_f32 v11, v11
    v_cvt_pk_bf16_f32 v68, v4, v5
    v_cvt_pk_bf16_f32 v69, v6, v7
    v_mfma_f32_32x32x8_bf16 v[20:35], v[122:123], v[94:95], v[20:35]
    v_exp_f32 v12, v12
    v_exp_f32 v13, v13
    v_exp_f32 v14, v14
    v_exp_f32 v15, v15
    v_cvt_pk_bf16_f32 v70, v8, v9
    v_cvt_pk_bf16_f32 v71, v10, v11
    v_mfma_f32_32x32x16_bf16 v[52:67], v[116:119], v[80:83], v[52:67]
    v_exp_f32 v16, v16
    v_exp_f32 v17, v17
    v_exp_f32 v18, v18
    v_exp_f32 v19, v19
    v_cvt_pk_bf16_f32 v72, v12, v13
    v_cvt_pk_bf16_f32 v73, v14, v15
    s_waitcnt lgkmcnt(0)
    v_mfma_f32_32x32x16_bf16 v[36:51], v[104:107], v[68:71], v[36:51]
    ds_read_b128 v[100:103], v1 offset:10752
    ds_read_b64 v[122:123], v2 offset:13824
    v_exp_f32 v20, v20
    v_exp_f32 v21, v21
    v_exp_f32 v22, v22
    v_exp_f32 v23, v23
    v_cvt_pk_bf16_f32 v74, v16, v17
    v_cvt_pk_bf16_f32 v75, v18, v19
    v_mfma_f32_32x32x16_bf16 v[4:19], v[96:99], v[84:87], 0
    ds_read_b128 v[112:115], v1 offset:11776
    ds_read_b128 v[116:119], v1 offset:12800
    v_exp_f32 v24, v24
    v_exp_f32 v25, v25
    v_exp_f32 v26, v26
    v_exp_f32 v27, v27
    v_cvt_pk_bf16_f32 v76, v20, v21
    v_cvt_pk_bf16_f32 v77, v22, v23
    v_mfma_f32_32x32x8_bf16 v[4:19], v[120:121], v[92:93], v[4:19]
    v_exp_f32 v28, v28
    v_exp_f32 v29, v29
    v_exp_f32 v30, v30
    v_exp_f32 v31, v31
    v_cvt_pk_bf16_f32 v78, v24, v25
    v_cvt_pk_bf16_f32 v79, v26, v27
    v_mfma_f32_32x32x16_bf16 v[36:51], v[108:111], v[72:75], v[36:51]
    v_exp_f32 v32, v32
    v_exp_f32 v33, v33
    v_exp_f32 v34, v34
    v_exp_f32 v35, v35
    v_cvt_pk_bf16_f32 v80, v28, v29
    v_cvt_pk_bf16_f32 v81, v30, v31
    v_mfma_f32_32x32x16_bf16 v[52:67], v[104:107], v[76:79], v[52:67]
    v_exp_f32 v4, v4
    v_exp_f32 v5, v5
    v_exp_f32 v6, v6
    v_exp_f32 v7, v7
    v_cvt_pk_bf16_f32 v82, v32, v33
    v_cvt_pk_bf16_f32 v83, v34, v35
    v_mfma_f32_32x32x16_bf16 v[20:35], v[96:99], v[88:91], 0
    v_exp_f32 v8, v8
    v_exp_f32 v9, v9
    v_exp_f32 v10, v10
    v_exp_f32 v11, v11
    v_cvt_pk_bf16_f32 v68, v4, v5
    v_cvt_pk_bf16_f32 v69, v6, v7
    v_mfma_f32_32x32x8_bf16 v[20:35], v[120:121], v[94:95], v[20:35]
    v_exp_f32 v12, v12
    v_exp_f32 v13, v13
    v_exp_f32 v14, v14
    v_exp_f32 v15, v15
    v_cvt_pk_bf16_f32 v70, v8, v9
    v_cvt_pk_bf16_f32 v71, v10, v11
    v_mfma_f32_32x32x16_bf16 v[52:67], v[108:111], v[80:83], v[52:67]
    v_exp_f32 v16, v16
    v_exp_f32 v17, v17
    v_exp_f32 v18, v18
    v_exp_f32 v19, v19
    v_cvt_pk_bf16_f32 v72, v12, v13
    v_cvt_pk_bf16_f32 v73, v14, v15
    s_waitcnt lgkmcnt(0)
    v_mfma_f32_32x32x16_bf16 v[36:51], v[112:115], v[68:71], v[36:51]
    ds_read_b128 v[96:99], v1 offset:14336
    ds_read_b64 v[120:121], v2 offset:17408
    v_exp_f32 v20, v20
    v_exp_f32 v21, v21
    v_exp_f32 v22, v22
    v_exp_f32 v23, v23
    v_cvt_pk_bf16_f32 v74, v16, v17
    v_cvt_pk_bf16_f32 v75, v18, v19
    v_mfma_f32_32x32x16_bf16 v[4:19], v[100:103], v[84:87], 0
    ds_read_b128 v[104:107], v1 offset:15360
    ds_read_b128 v[108:111], v1 offset:16384
    v_exp_f32 v24, v24
    v_exp_f32 v25, v25
    v_exp_f32 v26, v26
    v_exp_f32 v27, v27
    v_cvt_pk_bf16_f32 v76, v20, v21
    v_cvt_pk_bf16_f32 v77, v22, v23
    v_mfma_f32_32x32x8_bf16 v[4:19], v[122:123], v[92:93], v[4:19]
    v_exp_f32 v28, v28
    v_exp_f32 v29, v29
    v_exp_f32 v30, v30
    v_exp_f32 v31, v31
    v_cvt_pk_bf16_f32 v78, v24, v25
    v_cvt_pk_bf16_f32 v79, v26, v27
    v_mfma_f32_32x32x16_bf16 v[36:51], v[116:119], v[72:75], v[36:51]
    v_exp_f32 v32, v32
    v_exp_f32 v33, v33
    v_exp_f32 v34, v34
    v_exp_f32 v35, v35
    v_cvt_pk_bf16_f32 v80, v28, v29
    v_cvt_pk_bf16_f32 v81, v30, v31
    v_mfma_f32_32x32x16_bf16 v[52:67], v[112:115], v[76:79], v[52:67]
    v_exp_f32 v4, v4
    v_exp_f32 v5, v5
    v_exp_f32 v6, v6
    v_exp_f32 v7, v7
    v_cvt_pk_bf16_f32 v82, v32, v33
    v_cvt_pk_bf16_f32 v83, v34, v35
    v_mfma_f32_32x32x16_bf16 v[20:35], v[100:103], v[88:91], 0
    v_exp_f32 v8, v8
    v_exp_f32 v9, v9
    v_exp_f32 v10, v10
    v_exp_f32 v11, v11
    v_cvt_pk_bf16_f32 v68, v4, v5
    v_cvt_pk_bf16_f32 v69, v6, v7
    v_mfma_f32_32x32x8_bf16 v[20:35], v[122:123], v[94:95], v[20:35]
    v_exp_f32 v12, v12
    v_exp_f32 v13, v13
    v_exp_f32 v14, v14
    v_exp_f32 v15, v15
    v_cvt_pk_bf16_f32 v70, v8, v9
    v_cvt_pk_bf16_f32 v71, v10, v11
    v_mfma_f32_32x32x16_bf16 v[52:67], v[116:119], v[80:83], v[52:67]
    v_exp_f32 v16, v16
    v_exp_f32 v17, v17
    v_exp_f32 v18, v18
    v_exp_f32 v19, v19
    v_cvt_pk_bf16_f32 v72, v12, v13
    v_cvt_pk_bf16_f32 v73, v14, v15
    s_waitcnt lgkmcnt(0)
    v_mfma_f32_32x32x16_bf16 v[36:51], v[104:107], v[68:71], v[36:51]
    ds_read_b128 v[100:103], v1 offset:17920
    ds_read_b64 v[122:123], v2 offset:20992
    v_exp_f32 v20, v20
    v_exp_f32 v21, v21
    v_exp_f32 v22, v22
    v_exp_f32 v23, v23
    v_cvt_pk_bf16_f32 v74, v16, v17
    v_cvt_pk_bf16_f32 v75, v18, v19
    v_mfma_f32_32x32x16_bf16 v[4:19], v[96:99], v[84:87], 0
    ds_read_b128 v[112:115], v1 offset:18944
    ds_read_b128 v[116:119], v1 offset:19968
    v_exp_f32 v24, v24
    v_exp_f32 v25, v25
    v_exp_f32 v26, v26
    v_exp_f32 v27, v27
    v_cvt_pk_bf16_f32 v76, v20, v21
    v_cvt_pk_bf16_f32 v77, v22, v23
    v_mfma_f32_32x32x8_bf16 v[4:19], v[120:121], v[92:93], v[4:19]
    v_exp_f32 v28, v28
    v_exp_f32 v29, v29
    v_exp_f32 v30, v30
    v_exp_f32 v31, v31
    v_cvt_pk_bf16_f32 v78, v24, v25
    v_cvt_pk_bf16_f32 v79, v26, v27
    v_mfma_f32_32x32x16_bf16 v[36:51], v[108:111], v[72:75], v[36:51]
    v_exp_f32 v32, v32
    v_exp_f32 v33, v33
    v_exp_f32 v34, v34
    v_exp_f32 v35, v35
    v_cvt_pk_bf16_f32 v80, v28, v29
    v_cvt_pk_bf16_f32 v81, v30, v31
    v_mfma_f32_32x32x16_bf16 v[52:67], v[104:107], v[76:79], v[52:67]
    v_exp_f32 v4, v4
    v_exp_f32 v5, v5
    v_exp_f32 v6, v6
    v_exp_f32 v7, v7
    v_cvt_pk_bf16_f32 v82, v32, v33
    v_cvt_pk_bf16_f32 v83, v34, v35
    v_mfma_f32_32x32x16_bf16 v[20:35], v[96:99], v[88:91], 0
    v_exp_f32 v8, v8
    v_exp_f32 v9, v9
    v_exp_f32 v10, v10
    v_exp_f32 v11, v11
    v_cvt_pk_bf16_f32 v68, v4, v5
    v_cvt_pk_bf16_f32 v69, v6, v7
    v_mfma_f32_32x32x8_bf16 v[20:35], v[120:121], v[94:95], v[20:35]
    v_exp_f32 v12, v12
    v_exp_f32 v13, v13
    v_exp_f32 v14, v14
    v_exp_f32 v15, v15
    v_cvt_pk_bf16_f32 v70, v8, v9
    v_cvt_pk_bf16_f32 v71, v10, v11
    v_mfma_f32_32x32x16_bf16 v[52:67], v[108:111], v[80:83], v[52:67]
    v_exp_f32 v16, v16
    v_exp_f32 v17, v17
    v_exp_f32 v18, v18
    v_exp_f32 v19, v19
    v_cvt_pk_bf16_f32 v72, v12, v13
    v_cvt_pk_bf16_f32 v73, v14, v15
    s_waitcnt lgkmcnt(0)
    v_mfma_f32_32x32x16_bf16 v[36:51], v[112:115], v[68:71], v[36:51]
    ds_read_b128 v[96:99], v1 offset:21504
    ds_read_b64 v[120:121], v2 offset:24576
    v_exp_f32 v20, v20
    v_exp_f32 v21, v21
    v_exp_f32 v22, v22
    v_exp_f32 v23, v23
    v_cvt_pk_bf16_f32 v74, v16, v17
    v_cvt_pk_bf16_f32 v75, v18, v19
    v_mfma_f32_32x32x16_bf16 v[4:19], v[100:103], v[84:87], 0
    ds_read_b128 v[104:107], v1 offset:22528
    ds_read_b128 v[108:111], v1 offset:23552
    v_exp_f32 v24, v24
    v_exp_f32 v25, v25
    v_exp_f32 v26, v26
    v_exp_f32 v27, v27
    v_cvt_pk_bf16_f32 v76, v20, v21
    v_cvt_pk_bf16_f32 v77, v22, v23
    v_mfma_f32_32x32x8_bf16 v[4:19], v[122:123], v[92:93], v[4:19]
    v_exp_f32 v28, v28
    v_exp_f32 v29, v29
    v_exp_f32 v30, v30
    v_exp_f32 v31, v31
    v_cvt_pk_bf16_f32 v78, v24, v25
    v_cvt_pk_bf16_f32 v79, v26, v27
    v_mfma_f32_32x32x16_bf16 v[36:51], v[116:119], v[72:75], v[36:51]
    v_exp_f32 v32, v32
    v_exp_f32 v33, v33
    v_exp_f32 v34, v34
    v_exp_f32 v35, v35
    v_cvt_pk_bf16_f32 v80, v28, v29
    v_cvt_pk_bf16_f32 v81, v30, v31
    v_mfma_f32_32x32x16_bf16 v[52:67], v[112:115], v[76:79], v[52:67]
    v_exp_f32 v4, v4
    v_exp_f32 v5, v5
    v_exp_f32 v6, v6
    v_exp_f32 v7, v7
    v_cvt_pk_bf16_f32 v82, v32, v33
    v_cvt_pk_bf16_f32 v83, v34, v35
    v_mfma_f32_32x32x16_bf16 v[20:35], v[100:103], v[88:91], 0
    v_exp_f32 v8, v8
    v_exp_f32 v9, v9
    v_exp_f32 v10, v10
    v_exp_f32 v11, v11
    v_cvt_pk_bf16_f32 v68, v4, v5
    v_cvt_pk_bf16_f32 v69, v6, v7
    v_mfma_f32_32x32x8_bf16 v[20:35], v[122:123], v[94:95], v[20:35]
    v_exp_f32 v12, v12
    v_exp_f32 v13, v13
    v_exp_f32 v14, v14
    v_exp_f32 v15, v15
    v_cvt_pk_bf16_f32 v70, v8, v9
    v_cvt_pk_bf16_f32 v71, v10, v11
    v_mfma_f32_32x32x16_bf16 v[52:67], v[116:119], v[80:83], v[52:67]
    v_exp_f32 v16, v16
    v_exp_f32 v17, v17
    v_exp_f32 v18, v18
    v_exp_f32 v19, v19
    v_cvt_pk_bf16_f32 v72, v12, v13
    v_cvt_pk_bf16_f32 v73, v14, v15
    s_waitcnt lgkmcnt(0)
    v_mfma_f32_32x32x16_bf16 v[36:51], v[104:107], v[68:71], v[36:51]
    ds_read_b128 v[100:103], v1 offset:25088
    ds_read_b64 v[122:123], v2 offset:28160
    v_exp_f32 v20, v20
    v_exp_f32 v21, v21
    v_exp_f32 v22, v22
    v_exp_f32 v23, v23
    v_cvt_pk_bf16_f32 v74, v16, v17
    v_cvt_pk_bf16_f32 v75, v18, v19
    v_mfma_f32_32x32x16_bf16 v[4:19], v[96:99], v[84:87], 0
    ds_read_b128 v[112:115], v1 offset:26112
    ds_read_b128 v[116:119], v1 offset:27136
    v_exp_f32 v24, v24
    v_exp_f32 v25, v25
    v_exp_f32 v26, v26
    v_exp_f32 v27, v27
    v_cvt_pk_bf16_f32 v76, v20, v21
    v_cvt_pk_bf16_f32 v77, v22, v23
    v_mfma_f32_32x32x8_bf16 v[4:19], v[120:121], v[92:93], v[4:19]
    v_exp_f32 v28, v28
    v_exp_f32 v29, v29
    v_exp_f32 v30, v30
    v_exp_f32 v31, v31
    v_cvt_pk_bf16_f32 v78, v24, v25
    v_cvt_pk_bf16_f32 v79, v26, v27
    v_mfma_f32_32x32x16_bf16 v[36:51], v[108:111], v[72:75], v[36:51]
    v_exp_f32 v32, v32
    v_exp_f32 v33, v33
    v_exp_f32 v34, v34
    v_exp_f32 v35, v35
    v_cvt_pk_bf16_f32 v80, v28, v29
    v_cvt_pk_bf16_f32 v81, v30, v31
    v_mfma_f32_32x32x16_bf16 v[52:67], v[104:107], v[76:79], v[52:67]
    v_exp_f32 v4, v4
    v_exp_f32 v5, v5
    v_exp_f32 v6, v6
    v_exp_f32 v7, v7
    v_cvt_pk_bf16_f32 v82, v32, v33
    v_cvt_pk_bf16_f32 v83, v34, v35
    v_mfma_f32_32x32x16_bf16 v[20:35], v[96:99], v[88:91], 0
    v_exp_f32 v8, v8
    v_exp_f32 v9, v9
    v_exp_f32 v10, v10
    v_exp_f32 v11, v11
    v_cvt_pk_bf16_f32 v68, v4, v5
    v_cvt_pk_bf16_f32 v69, v6, v7
    v_mfma_f32_32x32x8_bf16 v[20:35], v[120:121], v[94:95], v[20:35]
    v_exp_f32 v12, v12
    v_exp_f32 v13, v13
    v_exp_f32 v14, v14
    v_exp_f32 v15, v15
    v_cvt_pk_bf16_f32 v70, v8, v9
    v_cvt_pk_bf16_f32 v71, v10, v11
    v_mfma_f32_32x32x16_bf16 v[52:67], v[108:111], v[80:83], v[52:67]
    v_exp_f32 v16, v16
    v_exp_f32 v17, v17
    v_exp_f32 v18, v18
    v_exp_f32 v19, v19
    v_cvt_pk_bf16_f32 v72, v12, v13
    v_cvt_pk_bf16_f32 v73, v14, v15
    s_waitcnt lgkmcnt(0)
    s_barrier
    v_add_u32 v1, s17, v1
    v_add_u32 v2, s17, v2
    s_sub_u32 s17, 0, s17
    v_mfma_f32_32x32x16_bf16 v[36:51], v[112:115], v[68:71], v[36:51]
    ds_read_b128 v[96:99], v1 offset:0
    ds_read_b64 v[120:121], v2 offset:3072
    v_exp_f32 v20, v20
    v_exp_f32 v21, v21
    v_exp_f32 v22, v22
    v_exp_f32 v23, v23
    v_cvt_pk_bf16_f32 v74, v16, v17
    v_cvt_pk_bf16_f32 v75, v18, v19
    v_mfma_f32_32x32x16_bf16 v[4:19], v[100:103], v[84:87], 0
    ds_read_b128 v[104:107], v1 offset:1024
    ds_read_b128 v[108:111], v1 offset:2048
    v_exp_f32 v24, v24
    v_exp_f32 v25, v25
    v_exp_f32 v26, v26
    v_exp_f32 v27, v27
    v_cvt_pk_bf16_f32 v76, v20, v21
    v_cvt_pk_bf16_f32 v77, v22, v23
    v_mfma_f32_32x32x8_bf16 v[4:19], v[122:123], v[92:93], v[4:19]
    v_exp_f32 v28, v28
    v_exp_f32 v29, v29
    v_exp_f32 v30, v30
    v_exp_f32 v31, v31
    v_cvt_pk_bf16_f32 v78, v24, v25
    v_cvt_pk_bf16_f32 v79, v26, v27
    v_mfma_f32_32x32x16_bf16 v[36:51], v[116:119], v[72:75], v[36:51]
    v_exp_f32 v32, v32
    v_exp_f32 v33, v33
    v_exp_f32 v34, v34
    v_exp_f32 v35, v35
    v_cvt_pk_bf16_f32 v80, v28, v29
    v_cvt_pk_bf16_f32 v81, v30, v31
    s_add_u32 s18, s18, 1
    s_cmp_lt_u32 s18, 8
    s_cbranch_scc1 L_attn_loop_2011
    v_cvt_pk_bf16_f32 v82, v32, v33
    v_cvt_pk_bf16_f32 v83, v34, v35
    s_nop 1
    v_mfma_f32_32x32x16_bf16 v[52:67], v[112:115], v[76:79], v[52:67]
    v_mfma_f32_32x32x16_bf16 v[52:67], v[116:119], v[80:83], v[52:67]
    s_nop 7
    s_nop 3
    v_lshrrev_b32 v4, 5, v0
    v_cmp_eq_u32 vcc, 0, v4
    s_mov_b64 s[26:27], 0
    s_mov_b32 s28, 0x1f800000
    s_mov_b32 s29, 0x5f800000
    v_cndmask_b32 v5, v44, v48, vcc
    v_pk_mul_f32 v[6:7], v[36:37], 0 op_sel_hi:[1,0]
    v_pk_fma_f32 v[6:7], v[38:39], 0, v[6:7] op_sel_hi:[1,0,1]
    v_pk_fma_f32 v[6:7], v[40:41], 0, v[6:7] op_sel_hi:[1,0,1]
    v_pk_fma_f32 v[6:7], v[42:43], 0, v[6:7] op_sel_hi:[1,0,1]
    v_pk_mul_f32 v[8:9], v[44:45], 0 op_sel_hi:[1,0]
    v_pk_fma_f32 v[8:9], v[46:47], 0, v[8:9] op_sel_hi:[1,0,1]
    v_cmp_nle_f32 s[22:23], s28, v5
    v_cmp_nge_f32 s[24:25], s29, v5
    v_cmp_u_f32 s[30:31], v6, v7
    v_cmp_u_f32 s[36:37], v8, v9
    s_nop 1
    s_or_b64 s[26:27], s[26:27], s[22:23]
    s_or_b64 s[26:27], s[26:27], s[24:25]
    s_or_b64 s[26:27], s[26:27], s[30:31]
    s_and_b64 s[36:37], s[36:37], vcc
    s_or_b64 s[26:27], s[26:27], s[36:37]
    v_cndmask_b32 v5, v60, v64, vcc
    v_pk_mul_f32 v[6:7], v[52:53], 0 op_sel_hi:[1,0]
    v_pk_fma_f32 v[6:7], v[54:55], 0, v[6:7] op_sel_hi:[1,0,1]
    v_pk_fma_f32 v[6:7], v[56:57], 0, v[6:7] op_sel_hi:[1,0,1]
    v_pk_fma_f32 v[6:7], v[58:59], 0, v[6:7] op_sel_hi:[1,0,1]
    v_pk_mul_f32 v[8:9], v[60:61], 0 op_sel_hi:[1,0]
    v_pk_fma_f32 v[8:9], v[62:63], 0, v[8:9] op_sel_hi:[1,0,1]
    v_cmp_nle_f32 s[22:23], s28, v5
    v_cmp_nge_f32 s[24:25], s29, v5
    v_cmp_u_f32 s[30:31], v6, v7
    v_cmp_u_f32 s[36:37], v8, v9
    s_nop 1
    s_or_b64 s[26:27], s[26:27], s[22:23]
    s_or_b64 s[26:27], s[26:27], s[24:25]
    s_or_b64 s[26:27], s[26:27], s[30:31]
    s_and_b64 s[36:37], s[36:37], vcc
    s_or_b64 s[26:27], s[26:27], s[36:37]
    s_cmp_eq_u64 s[26:27], 0
    s_cbranch_scc1 L_att_ok_2012
    v_lshlrev_b32 v5, 3, v0
    s_mul_i32 s22, s12, 147456
    s_add_u32 s22, s22, 4096
    s_lshr_b32 s21, s12, 1
    s_lshl_b32 s21, s21, 15
    s_add_u32 s21, s21, 5242880
    v_lshrrev_b32 v121, 5, v0
    v_mul_u32_u24 v121, 320, v121
    v_and_b32 v120, 31, v0
    v_lshl_add_u32 v120, v120, 4, v121
    s_and_b32 s23, s12, 1
    s_cmp_eq_u32 s23, 0
    s_cselect_b32 s36, -1, 0
    s_cselect_b32 s37, 0, -1
    v_mov_b32 v122, 0
    v_mov_b32 v123, 0
    v_mov_b32 v4, 0xff800000
    v_mov_b32 v6, 0xff800000
    s_mov_b32 s18, 0
L_fb_max_2014:
    s_add_u32 s24, s18, 63
    s_and_b32 s24, s24, 63
    s_lshl_b32 s25, s24, 9
    s_add_u32 s25, s25, s21
    s_mul_i32 s24, s24, 2304
    s_add_u32 s24, s24, s22
    buffer_load_dwordx4 v[116:119], v3, s[8:11], s24 offen
    s_mov_b64 exec, s[36:37]
    buffer_load_dwordx2 v[122:123], v5, s[8:11], s25 offen
    s_mov_b64 exec, -1
    s_waitcnt vmcnt(0)
    v_mfma_f32_32x32x16_bf16 v[20:35], v[116:119], v[84:87], 0
    v_mfma_f32_32x32x8_bf16 v[20:35], v[122:123], v[92:93], v[20:35]
    v_mfma_f32_32x32x16_bf16 v[100:115], v[116:119], v[88:91], 0
    v_mfma_f32_32x32x8_bf16 v[100:115], v[122:123], v[94:95], v[100:115]
    s_nop 7
    s_nop 7
    v_max3_f32 v4, v4, v20, v21
    v_max3_f32 v4, v4, v22, v23
    v_max3_f32 v4, v4, v24, v25
    v_max3_f32 v4, v4, v26, v27
    v_max3_f32 v4, v4, v28, v29
    v_max3_f32 v4, v4, v30, v31
    v_max3_f32 v4, v4, v32, v33
    v_max3_f32 v4, v4, v34, v35
    v_max3_f32 v6, v6, v100, v101
    v_max3_f32 v6, v6, v102, v103
    v_max3_f32 v6, v6, v104, v105
    v_max3_f32 v6, v6, v106, v107
    v_max3_f32 v6, v6, v108, v109
    v_max3_f32 v6, v6, v110, v111
    v_max3_f32 v6, v6, v112, v113
    v_max3_f32 v6, v6, v114, v115
    s_add_u32 s18, s18, 1
    s_cmp_lt_u32 s18, 64
    s_cbranch_scc1 L_fb_max_2014
    v_mov_b32 v7, v4
    s_nop 1
    v_permlane32_swap_b32 v4, v7
    s_nop 1
    v_max_f32 v4, v4, v7
    v_mov_b32 v7, v6
    s_nop 1
    v_permlane32_swap_b32 v6, v7
    s_nop 1
    v_max_f32 v6, v6, v7
    v_mov_b32 v36, 0
    v_mov_b32 v37, 0
    v_mov_b32 v38, 0
    v_mov_b32 v39, 0
    v_mov_b32 v40, 0
    v_mov_b32 v41, 0
    v_mov_b32 v42, 0
    v_mov_b32 v43, 0
    v_mov_b32 v44, 0
    v_mov_b32 v45, 0
    v_mov_b32 v46, 0
    v_mov_b32 v47, 0
    v_mov_b32 v48, 0
    v_mov_b32 v49, 0
    v_mov_b32 v50, 0
    v_mov_b32 v51, 0
    v_mov_b32 v52, 0
    v_mov_b32 v53, 0
    v_mov_b32 v54, 0
    v_mov_b32 v55, 0
    v_mov_b32 v56, 0
    v_mov_b32 v57, 0
    v_mov_b32 v58, 0
    v_mov_b32 v59, 0
    v_mov_b32 v60, 0
    v_mov_b32 v61, 0
    v_mov_b32 v62, 0
    v_mov_b32 v63, 0
    v_mov_b32 v64, 0
    v_mov_b32 v65, 0
    v_mov_b32 v66, 0
    v_mov_b32 v67, 0
    v_and_b32 v7, 31, v0
    v_cmp_eq_u32 s[24:25], 20, v7
    v_cmp_eq_u32 vcc, 24, v7
    v_mov_b32 v7, 0x3f803f80
    s_nop 1
    s_or_b64 vcc, vcc, s[24:25]
    s_nop 1
    v_cndmask_b32 v68, 0, v7, vcc
    v_cndmask_b32 v69, 0, v7, vcc
    v_cndmask_b32 v70, 0, v7, vcc
    v_cndmask_b32 v71, 0, v7, vcc
    v_cndmask_b32 v72, 0, v7, vcc
    v_cndmask_b32 v73, 0, v7, vcc
    v_cndmask_b32 v74, 0, v7, vcc
    v_cndmask_b32 v75, 0, v7, vcc
    s_mov_b32 s38, 0x000fffff
    s_mov_b32 s39, 0x000fffff
    s_mov_b32 s18, 0
L_fb_main_2015:
    s_add_u32 s24, s18, 63
    s_and_b32 s24, s24, 63
    s_lshl_b32 s25, s24, 9
    s_add_u32 s25, s25, s21
    s_mul_i32 s24, s24, 2304
    s_add_u32 s24, s24, s22
    buffer_load_dwordx4 v[116:119], v3, s[8:11], s24 offen
    s_mov_b64 exec, s[36:37]
    buffer_load_dwordx2 v[122:123], v5, s[8:11], s25 offen
    s_mov_b64 exec, -1
    s_mul_i32 s24, s18, 2304
    s_add_u32 s24, s24, s22
    s_mov_b64 exec, s[38:39]
    buffer_load_dwordx4 v[68:71], v120, s[8:11], s24 offen offset:1024
    buffer_load_dwordx4 v[72:75], v120, s[8:11], s24 offen offset:1664
    s_mov_b64 exec, -1
    s_waitcnt vmcnt(0)
    v_mfma_f32_32x32x16_bf16 v[20:35], v[116:119], v[84:87], 0
    v_mfma_f32_32x32x8_bf16 v[20:35], v[122:123], v[92:93], v[20:35]
    v_mfma_f32_32x32x16_bf16 v[100:115], v[116:119], v[88:91], 0
    v_mfma_f32_32x32x8_bf16 v[100:115], v[122:123], v[94:95], v[100:115]
    s_nop 7
    s_nop 7
    v_sub_f32 v20, v20, v4
    v_sub_f32 v21, v21, v4
    v_sub_f32 v22, v22, v4
    v_sub_f32 v23, v23, v4
    v_sub_f32 v24, v24, v4
    v_sub_f32 v25, v25, v4
    v_sub_f32 v26, v26, v4
    v_sub_f32 v27, v27, v4
    v_sub_f32 v28, v28, v4
    v_sub_f32 v29, v29, v4
    v_sub_f32 v30, v30, v4
    v_sub_f32 v31, v31, v4
    v_sub_f32 v32, v32, v4
    v_sub_f32 v33, v33, v4
    v_sub_f32 v34, v34, v4
    v_sub_f32 v35, v35, v4
    v_exp_f32 v20, v20
    v_exp_f32 v21, v21
    v_exp_f32 v22, v22
    v_exp_f32 v23, v23
    v_exp_f32 v24, v24
    v_exp_f32 v25, v25
    v_exp_f32 v26, v26
    v_exp_f32 v27, v27
    v_exp_f32 v28, v28
    v_exp_f32 v29, v29
    v_exp_f32 v30, v30
    v_exp_f32 v31, v31
    v_exp_f32 v32, v32
    v_exp_f32 v33, v33
    v_exp_f32 v34, v34
    v_exp_f32 v35, v35
    s_nop 0
    v_cvt_pk_bf16_f32 v76, v20, v21
    v_cvt_pk_bf16_f32 v77, v22, v23
    v_cvt_pk_bf16_f32 v78, v24, v25
    v_cvt_pk_bf16_f32 v79, v26, v27
    v_cvt_pk_bf16_f32 v80, v28, v29
    v_cvt_pk_bf16_f32 v81, v30, v31
    v_cvt_pk_bf16_f32 v82, v32, v33
    v_cvt_pk_bf16_f32 v83, v34, v35
    s_nop 1
    v_mfma_f32_32x32x16_bf16 v[36:51], v[68:71], v[76:79], v[36:51]
    v_mfma_f32_32x32x16_bf16 v[36:51], v[72:75], v[80:83], v[36:51]
    v_sub_f32 v100, v100, v6
    v_sub_f32 v101, v101, v6
    v_sub_f32 v102, v102, v6
    v_sub_f32 v103, v103, v6
    v_sub_f32 v104, v104, v6
    v_sub_f32 v105, v105, v6
    v_sub_f32 v106, v106, v6
    v_sub_f32 v107, v107, v6
    v_sub_f32 v108, v108, v6
    v_sub_f32 v109, v109, v6
    v_sub_f32 v110, v110, v6
    v_sub_f32 v111, v111, v6
    v_sub_f32 v112, v112, v6
    v_sub_f32 v113, v113, v6
    v_sub_f32 v114, v114, v6
    v_sub_f32 v115, v115, v6
    v_exp_f32 v100, v100
    v_exp_f32 v101, v101
    v_exp_f32 v102, v102
    v_exp_f32 v103, v103
    v_exp_f32 v104, v104
    v_exp_f32 v105, v105
    v_exp_f32 v106, v106
    v_exp_f32 v107, v107
    v_exp_f32 v108, v108
    v_exp_f32 v109, v109
    v_exp_f32 v110, v110
    v_exp_f32 v111, v111
    v_exp_f32 v112, v112
    v_exp_f32 v113, v113
    v_exp_f32 v114, v114
    v_exp_f32 v115, v115
    s_nop 0
    v_cvt_pk_bf16_f32 v8, v100, v101
    v_cvt_pk_bf16_f32 v9, v102, v103
    v_cvt_pk_bf16_f32 v10, v104, v105
    v_cvt_pk_bf16_f32 v11, v106, v107
    v_cvt_pk_bf16_f32 v12, v108, v109
    v_cvt_pk_bf16_f32 v13, v110, v111
    v_cvt_pk_bf16_f32 v14, v112, v113
    v_cvt_pk_bf16_f32 v15, v114, v115
    s_nop 1
    v_mfma_f32_32x32x16_bf16 v[52:67], v[68:71], v[8:11], v[52:67]
    v_mfma_f32_32x32x16_bf16 v[52:67], v[72:75], v[12:15], v[52:67]
    s_add_u32 s18, s18, 1
    s_cmp_lt_u32 s18, 64
    s_cbranch_scc1 L_fb_main_2015
    s_nop 7
    s_nop 7
    s_branch L_att_ok_2012
L_att_ok_2012:
    v_and_b32 v84, 31, v0
    v_lshrrev_b32 v85, 5, v0
    v_cmp_eq_u32 vcc, 0, v85
    s_mul_i32 s20, s14, 3072
    s_add_u32 s20, s20, 61440
    v_mul_u32_u24 v84, 48, v84
    v_lshl_add_u32 v84, v85, 3, v84
    v_add_u32 v84, s20, v84
    v_lshlrev_b32 v86, 4, v0
    v_add_u32 v94, s20, v86
    s_lshl_b32 s21, s13, 1
    s_lshr_b32 s22, s14, 1
    s_add_u32 s21, s21, s22
    s_lshl_b32 s21, s21, 5
    s_add_u32 s21, s21, s12
    s_mul_i32 s21, s21, 6144
    s_and_b32 s22, s14, 1
    s_mul_i32 s22, s22, 3072
    s_add_u32 s22, s22, s21
    s_add_u32 s22, s22, 17825792
    s_nop 1
    v_cndmask_b32 v87, v44, v48, vcc
    v_rcp_f32 v87, v87
    s_nop 0
    v_mul_f32 v36, v36, v87
    v_mul_f32 v37, v37, v87
    v_mul_f32 v38, v38, v87
    v_mul_f32 v39, v39, v87
    v_mul_f32 v40, v40, v87
    v_mul_f32 v41, v41, v87
    v_mul_f32 v42, v42, v87
    v_mul_f32 v43, v43, v87
    v_mul_f32 v44, v44, v87
    v_mul_f32 v45, v45, v87
    v_mul_f32 v46, v46, v87
    v_mul_f32 v47, v47, v87
    v_cvt_pk_bf16_f32 v88, v36, v37
    v_cvt_pk_bf16_f32 v89, v38, v39
    v_cvt_pk_bf16_f32 v90, v40, v41
    v_cvt_pk_bf16_f32 v91, v42, v43
    v_cvt_pk_bf16_f32 v92, v44, v45
    v_cvt_pk_bf16_f32 v93, v46, v47
    v_cndmask_b32 v92, 0, v92, vcc
    v_cndmask_b32 v93, 0, v93, vcc
    ds_write_b64 v84, v[88:89] offset:0
    ds_write_b64 v84, v[90:91] offset:16
    ds_write_b64 v84, v[92:93] offset:32
    s_nop 7
    v_cndmask_b32 v87, v60, v64, vcc
    v_rcp_f32 v87, v87
    s_nop 0
    v_mul_f32 v52, v52, v87
    v_mul_f32 v53, v53, v87
    v_mul_f32 v54, v54, v87
    v_mul_f32 v55, v55, v87
    v_mul_f32 v56, v56, v87
    v_mul_f32 v57, v57, v87
    v_mul_f32 v58, v58, v87
    v_mul_f32 v59, v59, v87
    v_mul_f32 v60, v60, v87
    v_mul_f32 v61, v61, v87
    v_mul_f32 v62, v62, v87
    v_mul_f32 v63, v63, v87
    v_cvt_pk_bf16_f32 v88, v52, v53
    v_cvt_pk_bf16_f32 v89, v54, v55
    v_cvt_pk_bf16_f32 v90, v56, v57
    v_cvt_pk_bf16_f32 v91, v58, v59
    v_cvt_pk_bf16_f32 v92, v60, v61
    v_cvt_pk_bf16_f32 v93, v62, v63
    v_cndmask_b32 v92, 0, v92, vcc
    v_cndmask_b32 v93, 0, v93, vcc
    ds_write_b64 v84, v[88:89] offset:1536
    ds_write_b64 v84, v[90:91] offset:1552
    ds_write_b64 v84, v[92:93] offset:1568
    s_waitcnt lgkmcnt(0)
    ds_read_b128 v[4:7], v94
    ds_read_b128 v[8:11], v94 offset:1024
    ds_read_b128 v[12:15], v94 offset:2048
    s_waitcnt lgkmcnt(0)
    buffer_store_dwordx4 v[4:7], v86, s[8:11], s22 offen sc1
    buffer_store_dwordx4 v[8:11], v86, s[8:11], s22 offen offset:1024 sc1
    buffer_store_dwordx4 v[12:15], v86, s[8:11], s22 offen offset:2048 sc1
    s_waitcnt vmcnt(0) lgkmcnt(0)
    s_barrier
    s_cmp_lg_u32 s14, 0
    s_cbranch_scc1 L_att_noflag_2016
    s_lshl_b32 s20, s13, 7
    s_add_u32 s20, s20, 15206400
    s_lshl_b32 s21, s12, 2
    v_mov_b32 v84, s21
    v_mov_b32 v85, s98
    s_mov_b64 exec, 1
    buffer_store_dword v85, v84, s[8:11], s20 offen sc1
    s_mov_b64 exec, -1
L_att_noflag_2016:
    s_bitcmp1_b32 s2, 3
    s_cbranch_scc1 L_att_exit_2017
    s_mov_b32 s60, s14
    s_mov_b32 s20, s60
    s_setprio 0
    s_mov_b32 s42, 1
L_out_compute_shared:
    s_load_dwordx2 s[8:9], s[0:1], 72
    s_load_dwordx2 s[16:17], s[0:1], 56
    s_load_dwordx2 s[12:13], s[0:1], 24
    s_load_dwordx2 s[46:47], s[0:1], 48
    s_load_dwordx2 s[62:63], s[0:1], 72
    s_and_b32 s25, s2, 7
    s_lshr_b32 s26, s2, 4
    s_lshl_b32 s40, s25, 1
    s_lshr_b32 s27, s26, 3
    s_add_u32 s40, s40, s27
    s_and_b32 s41, s26, 7
    s_mul_i32 s28, s40, 196608
    s_mul_i32 s29, s42, -3145728
    s_add_u32 s28, s28, s29
    s_add_u32 s28, s28, 20971520
    s_waitcnt lgkmcnt(0)
    s_cmp_eq_u32 s42, 0
    s_cselect_b32 s12, s12, s46
    s_cselect_b32 s13, s13, s47
    s_add_u32 s8, s8, s28
    s_addc_u32 s9, s9, 0
    s_mov_b32 s10, 196608
    s_mov_b32 s11, 0x00020000
    s_mov_b32 s14, 819200
    s_mov_b32 s15, 0x00020000
    s_mov_b32 s18, 5242880
    s_mov_b32 s19, 0x00020000
    s_mov_b32 s64, s62
    s_mov_b32 s65, s63
    s_mov_b32 s66, 33554432
    s_mov_b32 s67, 0x00020000
    v_and_b32 v64, 31, v0
    s_lshl_b32 s25, s20, 5
    v_add_u32 v64, s25, v64
    v_mul_u32_u24 v64, 48, v64
    v_lshrrev_b32 v65, 5, v0
    v_lshl_add_u32 v1, v65, 4, v64
    v_mul_u32_u24 v66, 6144, v65
    v_add3_u32 v2, v64, v66, 32
    v_bfe_u32 v64, v0, 2, 2
    v_bfe_u32 v66, v0, 4, 1
    v_lshlrev_b32 v66, 5, v66
    v_and_b32 v4, 3, v0
    v_lshl_add_u32 v66, v4, 3, v66
    v_add_u32 v66, 49152, v66
    s_and_b32 s25, s41, 1
    s_lshl_b32 s25, s25, 5
    v_add_u32 v66, s25, v66
    v_lshl_add_u32 v3, v65, 3, v64
    v_mul_u32_u24 v3, 192, v3
    v_add_u32 v3, v3, v66
    v_mul_u32_u24 v4, 20, v65
    v_add3_u32 v4, v4, v64, 16
    v_mul_u32_u24 v4, 192, v4
    v_add_u32 v4, v4, v66
    v_mov_b32 v80, 0
    v_mov_b32 v81, 0
    v_mov_b32 v82, 0
    v_mov_b32 v83, 0
    v_mov_b32 v84, 0
    v_mov_b32 v85, 0
    v_mov_b32 v86, 0
    v_mov_b32 v87, 0
    v_mov_b32 v88, 0
    v_mov_b32 v89, 0
    v_mov_b32 v90, 0
    v_mov_b32 v91, 0
    v_mov_b32 v92, 0
    v_mov_b32 v93, 0
    v_mov_b32 v94, 0
    v_mov_b32 v95, 0
    v_mov_b32 v96, 0
    v_mov_b32 v97, 0
    v_mov_b32 v98, 0
    v_mov_b32 v99, 0
    v_mov_b32 v100, 0
    v_mov_b32 v101, 0
    v_mov_b32 v102, 0
    v_mov_b32 v103, 0
    v_mov_b32 v104, 0
    v_mov_b32 v105, 0
    v_mov_b32 v106, 0
    v_mov_b32 v107, 0
    v_mov_b32 v108, 0
    v_mov_b32 v109, 0
    v_mov_b32 v110, 0
    v_mov_b32 v111, 0
    v_mov_b32 v112, 0
    v_mov_b32 v113, 0
    v_mov_b32 v114, 0
    v_mov_b32 v115, 0
    v_mov_b32 v116, 0
    v_mov_b32 v117, 0
    v_mov_b32 v118, 0
    v_mov_b32 v119, 0
    v_mov_b32 v120, 0
    v_mov_b32 v121, 0
    v_mov_b32 v122, 0
    v_mov_b32 v123, 0
    v_mov_b32 v124, 0
    v_mov_b32 v125, 0
    v_mov_b32 v126, 0
    v_mov_b32 v127, 0
    s_barrier
    s_barrier
    ds_read_b128 v[8:11], v1 offset:0
    ds_read_b64_tr_b16 v[16:17], v3 offset:0
    ds_read_b64_tr_b16 v[18:19], v3 offset:768
    ds_read_b64_tr_b16 v[20:21], v3 offset:64
    ds_read_b64_tr_b16 v[22:23], v3 offset:832
    ds_read_b64_tr_b16 v[24:25], v3 offset:128
    ds_read_b64_tr_b16 v[26:27], v3 offset:896
    s_mov_b32 s35, 0
L_oc_loop_2018:
    s_waitcnt lgkmcnt(4)
    v_mfma_f32_32x32x16_bf16 v[80:95], v[16:19], v[8:11], v[80:95]
    ds_read_b128 v[12:15], v1 offset:6144
    ds_read_b64_tr_b16 v[28:29], v3 offset:3840
    ds_read_b64_tr_b16 v[30:31], v3 offset:4608
    s_waitcnt lgkmcnt(5)
    v_mfma_f32_32x32x16_bf16 v[96:111], v[20:23], v[8:11], v[96:111]
    ds_read_b64_tr_b16 v[32:33], v3 offset:3904
    ds_read_b64_tr_b16 v[34:35], v3 offset:4672
    s_waitcnt lgkmcnt(5)
    v_mfma_f32_32x32x16_bf16 v[112:127], v[24:27], v[8:11], v[112:127]
    ds_read_b64_tr_b16 v[36:37], v3 offset:3968
    ds_read_b64_tr_b16 v[38:39], v3 offset:4736
    s_waitcnt lgkmcnt(4)
    v_mfma_f32_32x32x16_bf16 v[80:95], v[28:31], v[12:15], v[80:95]
    ds_read_b64 v[8:9], v2 offset:0
    ds_read_b64_tr_b16 v[16:17], v4 offset:0
    s_waitcnt lgkmcnt(4)
    v_mfma_f32_32x32x16_bf16 v[96:111], v[32:35], v[12:15], v[96:111]
    ds_read_b64_tr_b16 v[20:21], v4 offset:64
    s_waitcnt lgkmcnt(3)
    v_mfma_f32_32x32x16_bf16 v[112:127], v[36:39], v[12:15], v[112:127]
    ds_read_b64_tr_b16 v[24:25], v4 offset:128
    s_waitcnt lgkmcnt(0)
    s_barrier
    v_mfma_f32_32x32x8_bf16 v[80:95], v[16:17], v[8:9], v[80:95]
    ds_read_b128 v[12:15], v1 offset:12288
    ds_read_b64_tr_b16 v[28:29], v3 offset:8192
    ds_read_b64_tr_b16 v[30:31], v3 offset:8960
    v_mfma_f32_32x32x8_bf16 v[96:111], v[20:21], v[8:9], v[96:111]
    ds_read_b64_tr_b16 v[32:33], v3 offset:8256
    ds_read_b64_tr_b16 v[34:35], v3 offset:9024
    v_mfma_f32_32x32x8_bf16 v[112:127], v[24:25], v[8:9], v[112:127]
    ds_read_b64_tr_b16 v[36:37], v3 offset:8320
    ds_read_b64_tr_b16 v[38:39], v3 offset:9088
    s_waitcnt lgkmcnt(4)
    v_mfma_f32_32x32x16_bf16 v[80:95], v[28:31], v[12:15], v[80:95]
    ds_read_b128 v[8:11], v1 offset:18432
    ds_read_b64_tr_b16 v[16:17], v3 offset:12032
    ds_read_b64_tr_b16 v[18:19], v3 offset:12800
    s_waitcnt lgkmcnt(5)
    v_mfma_f32_32x32x16_bf16 v[96:111], v[32:35], v[12:15], v[96:111]
    ds_read_b64_tr_b16 v[20:21], v3 offset:12096
    ds_read_b64_tr_b16 v[22:23], v3 offset:12864
    s_waitcnt lgkmcnt(5)
    v_mfma_f32_32x32x16_bf16 v[112:127], v[36:39], v[12:15], v[112:127]
    ds_read_b64_tr_b16 v[24:25], v3 offset:12160
    ds_read_b64_tr_b16 v[26:27], v3 offset:12928
    s_waitcnt lgkmcnt(4)
    v_mfma_f32_32x32x16_bf16 v[80:95], v[16:19], v[8:11], v[80:95]
    ds_read_b64 v[12:13], v2 offset:12288
    ds_read_b64_tr_b16 v[28:29], v4 offset:8192
    s_waitcnt lgkmcnt(4)
    v_mfma_f32_32x32x16_bf16 v[96:111], v[20:23], v[8:11], v[96:111]
    ds_read_b64_tr_b16 v[32:33], v4 offset:8256
    s_waitcnt lgkmcnt(3)
    v_mfma_f32_32x32x16_bf16 v[112:127], v[24:27], v[8:11], v[112:127]
    ds_read_b64_tr_b16 v[36:37], v4 offset:8320
    s_waitcnt lgkmcnt(0)
    s_barrier
    v_mfma_f32_32x32x8_bf16 v[80:95], v[28:29], v[12:13], v[80:95]
    ds_read_b128 v[8:11], v1 offset:24576
    ds_read_b64_tr_b16 v[16:17], v3 offset:16384
    ds_read_b64_tr_b16 v[18:19], v3 offset:17152
    v_mfma_f32_32x32x8_bf16 v[96:111], v[32:33], v[12:13], v[96:111]
    ds_read_b64_tr_b16 v[20:21], v3 offset:16448
    ds_read_b64_tr_b16 v[22:23], v3 offset:17216
    v_mfma_f32_32x32x8_bf16 v[112:127], v[36:37], v[12:13], v[112:127]
    ds_read_b64_tr_b16 v[24:25], v3 offset:16512
    ds_read_b64_tr_b16 v[26:27], v3 offset:17280
    s_waitcnt lgkmcnt(4)
    v_mfma_f32_32x32x16_bf16 v[80:95], v[16:19], v[8:11], v[80:95]
    ds_read_b128 v[12:15], v1 offset:30720
    ds_read_b64_tr_b16 v[28:29], v3 offset:20224
    ds_read_b64_tr_b16 v[30:31], v3 offset:20992
    s_waitcnt lgkmcnt(5)
    v_mfma_f32_32x32x16_bf16 v[96:111], v[20:23], v[8:11], v[96:111]
    ds_read_b64_tr_b16 v[32:33], v3 offset:20288
    ds_read_b64_tr_b16 v[34:35], v3 offset:21056
    s_waitcnt lgkmcnt(5)
    v_mfma_f32_32x32x16_bf16 v[112:127], v[24:27], v[8:11], v[112:127]
    ds_read_b64_tr_b16 v[36:37], v3 offset:20352
    ds_read_b64_tr_b16 v[38:39], v3 offset:21120
    s_waitcnt lgkmcnt(4)
    v_mfma_f32_32x32x16_bf16 v[80:95], v[28:31], v[12:15], v[80:95]
    ds_read_b64 v[8:9], v2 offset:24576
    ds_read_b64_tr_b16 v[16:17], v4 offset:16384
    s_waitcnt lgkmcnt(4)
    v_mfma_f32_32x32x16_bf16 v[96:111], v[32:35], v[12:15], v[96:111]
    ds_read_b64_tr_b16 v[20:21], v4 offset:16448
    s_waitcnt lgkmcnt(3)
    v_mfma_f32_32x32x16_bf16 v[112:127], v[36:39], v[12:15], v[112:127]
    ds_read_b64_tr_b16 v[24:25], v4 offset:16512
    s_waitcnt lgkmcnt(0)
    s_barrier
    v_mfma_f32_32x32x8_bf16 v[80:95], v[16:17], v[8:9], v[80:95]
    ds_read_b128 v[12:15], v1 offset:36864
    ds_read_b64_tr_b16 v[28:29], v3 offset:24576
    ds_read_b64_tr_b16 v[30:31], v3 offset:25344
    v_mfma_f32_32x32x8_bf16 v[96:111], v[20:21], v[8:9], v[96:111]
    ds_read_b64_tr_b16 v[32:33], v3 offset:24640
    ds_read_b64_tr_b16 v[34:35], v3 offset:25408
    v_mfma_f32_32x32x8_bf16 v[112:127], v[24:25], v[8:9], v[112:127]
    ds_read_b64_tr_b16 v[36:37], v3 offset:24704
    ds_read_b64_tr_b16 v[38:39], v3 offset:25472
    s_waitcnt lgkmcnt(4)
    v_mfma_f32_32x32x16_bf16 v[80:95], v[28:31], v[12:15], v[80:95]
    ds_read_b128 v[8:11], v1 offset:43008
    ds_read_b64_tr_b16 v[16:17], v3 offset:28416
    ds_read_b64_tr_b16 v[18:19], v3 offset:29184
    s_waitcnt lgkmcnt(5)
    v_mfma_f32_32x32x16_bf16 v[96:111], v[32:35], v[12:15], v[96:111]
    ds_read_b64_tr_b16 v[20:21], v3 offset:28480
    ds_read_b64_tr_b16 v[22:23], v3 offset:29248
    s_waitcnt lgkmcnt(5)
    v_mfma_f32_32x32x16_bf16 v[112:127], v[36:39], v[12:15], v[112:127]
    ds_read_b64_tr_b16 v[24:25], v3 offset:28544
    ds_read_b64_tr_b16 v[26:27], v3 offset:29312
    s_waitcnt lgkmcnt(4)
    v_mfma_f32_32x32x16_bf16 v[80:95], v[16:19], v[8:11], v[80:95]
    ds_read_b64 v[12:13], v2 offset:36864
    ds_read_b64_tr_b16 v[28:29], v4 offset:24576
    s_waitcnt lgkmcnt(4)
    v_mfma_f32_32x32x16_bf16 v[96:111], v[20:23], v[8:11], v[96:111]
    ds_read_b64_tr_b16 v[32:33], v4 offset:24640
    s_waitcnt lgkmcnt(3)
    v_mfma_f32_32x32x16_bf16 v[112:127], v[24:27], v[8:11], v[112:127]
    ds_read_b64_tr_b16 v[36:37], v4 offset:24704
    s_waitcnt lgkmcnt(0)
    s_cmp_eq_u32 s35, 3
    s_cbranch_scc1 L_oc_nobar_2019
    s_barrier
L_oc_nobar_2019:
    v_mfma_f32_32x32x8_bf16 v[80:95], v[28:29], v[12:13], v[80:95]
    ds_read_b128 v[8:11], v1 offset:0
    ds_read_b64_tr_b16 v[16:17], v3 offset:0
    ds_read_b64_tr_b16 v[18:19], v3 offset:768
    v_mfma_f32_32x32x8_bf16 v[96:111], v[32:33], v[12:13], v[96:111]
    ds_read_b64_tr_b16 v[20:21], v3 offset:64
    ds_read_b64_tr_b16 v[22:23], v3 offset:832
    v_mfma_f32_32x32x8_bf16 v[112:127], v[36:37], v[12:13], v[112:127]
    ds_read_b64_tr_b16 v[24:25], v3 offset:128
    ds_read_b64_tr_b16 v[26:27], v3 offset:896
    s_add_u32 s35, s35, 1
    s_cmp_lt_u32 s35, 4
    s_cbranch_scc1 L_oc_loop_2018
    s_waitcnt lgkmcnt(0)
    s_waitcnt vmcnt(0)
    v_and_b32 v64, 31, v0
    s_lshl_b32 s25, s40, 7
    s_lshl_b32 s26, s20, 5
    s_add_u32 s25, s25, s26
    v_add_u32 v64, s25, v64
    v_mul_u32_u24 v64, 2560, v64
    v_lshrrev_b32 v65, 5, v0
    v_lshlrev_b32 v65, 4, v65
    v_add_u32 v64, v64, v65
    s_mul_i32 s27, s42, 1280
    s_mul_i32 s28, s41, 160
    s_add_u32 s27, s27, s28
    s_nop 7
    s_nop 3
    v_cvt_pk_bf16_f32 v68, v80, v81
    v_cvt_pk_bf16_f32 v69, v82, v83
    v_cvt_pk_bf16_f32 v70, v84, v85
    v_cvt_pk_bf16_f32 v71, v86, v87
    s_nop 1
    v_permlane32_swap_b32 v68, v70
    v_permlane32_swap_b32 v69, v71
    s_nop 1
    buffer_store_dwordx4 v[68:71], v64, s[16:19], s27 offen offset:0
    v_cvt_pk_bf16_f32 v72, v88, v89
    v_cvt_pk_bf16_f32 v73, v90, v91
    v_cvt_pk_bf16_f32 v74, v92, v93
    v_cvt_pk_bf16_f32 v75, v94, v95
    s_nop 1
    v_permlane32_swap_b32 v72, v74
    v_permlane32_swap_b32 v73, v75
    s_nop 1
    buffer_store_dwordx4 v[72:75], v64, s[16:19], s27 offen offset:32
    v_cvt_pk_bf16_f32 v68, v96, v97
    v_cvt_pk_bf16_f32 v69, v98, v99
    v_cvt_pk_bf16_f32 v70, v100, v101
    v_cvt_pk_bf16_f32 v71, v102, v103
    s_nop 1
    v_permlane32_swap_b32 v68, v70
    v_permlane32_swap_b32 v69, v71
    s_nop 1
    buffer_store_dwordx4 v[68:71], v64, s[16:19], s27 offen offset:64
    v_cvt_pk_bf16_f32 v72, v104, v105
    v_cvt_pk_bf16_f32 v73, v106, v107
    v_cvt_pk_bf16_f32 v74, v108, v109
    v_cvt_pk_bf16_f32 v75, v110, v111
    s_nop 1
    v_permlane32_swap_b32 v72, v74
    v_permlane32_swap_b32 v73, v75
    s_nop 1
    buffer_store_dwordx4 v[72:75], v64, s[16:19], s27 offen offset:96
    v_cvt_pk_bf16_f32 v68, v112, v113
    v_cvt_pk_bf16_f32 v69, v114, v115
    v_cvt_pk_bf16_f32 v70, v116, v117
    v_cvt_pk_bf16_f32 v71, v118, v119
    s_nop 1
    v_permlane32_swap_b32 v68, v70
    v_permlane32_swap_b32 v69, v71
    s_nop 1
    buffer_store_dwordx4 v[68:71], v64, s[16:19], s27 offen offset:128
    s_endpgm
L_att_exit_2017:
    s_endpgm
L_arole_2002:
    s_mov_b32 s54, s2
    s_sub_u32 s2, s2, 256
    s_load_dwordx2 s[8:9], s[0:1], 0
    s_load_dwordx2 s[12:13], s[0:1], 8
    s_load_dwordx2 s[16:17], s[0:1], 72
    s_load_dwordx2 s[44:45], s[0:1], 16
    v_lshrrev_b32 v3, 6, v0
    v_and_b32 v0, 63, v0
    v_readfirstlane_b32 s20, v3
    s_nop 3
    s_lshr_b32 s39, s20, 2
    s_and_b32 s20, s20, 3
    s_and_b32 s25, s2, 7
    s_lshr_b32 s26, s2, 3
    s_lshr_b32 s27, s25, 1
    s_lshl_b32 s40, s27, 2
    s_lshr_b32 s27, s26, 3
    s_add_u32 s40, s40, s27
    s_and_b32 s41, s25, 1
    s_lshl_b32 s41, s41, 3
    s_and_b32 s27, s26, 7
    s_add_u32 s41, s41, s27
    s_mul_i32 s21, s40, 163840
    s_mul_i32 s22, s41, 80
    s_mov_b32 s52, 0x3fb8aa3b
    s_mov_b32 s53, 0xbfb8aa3b
    s_mov_b32 s100, 0x3fb8aa3b
    s_mov_b32 s101, 0x3fb8aa3b
    s_mov_b32 s86, 0xbfb8aa3b
    s_mov_b32 s87, 0xbfb8aa3b
    s_waitcnt lgkmcnt(0)
    s_mov_b32 s10, 2621440
    s_mov_b32 s11, 0x00020000
    s_mov_b32 s14, 2457600
    s_mov_b32 s15, 0x00020000
    s_mov_b32 s18, 33554432
    s_mov_b32 s19, 0x00020000
    s_mov_b32 s46, 25600
    s_mov_b32 s47, 0x00020000
    s_and_b32 s33, s40, 3
    s_mul_i32 s33, s33, 10
    s_and_b32 s34, s41, 7
    s_mul_i32 s34, s34, 5
    s_add_u32 s33, s33, s34
    s_lshr_b32 s33, s33, 1
    s_cmp_ge_u32 s33, 20
    s_cselect_b32 s34, 20, 0
    s_sub_u32 s59, s33, s34
    s_mov_b32 s98, 1
    s_cmp_eq_u32 s39, 0
    s_cbranch_scc1 L_compute_2020
    v_lshrrev_b32 v3, 2, v0
    v_lshrrev_b32 v4, 4, v0
    v_and_b32 v5, 3, v0
    v_xor_b32 v5, v5, v4
    v_lshlrev_b32 v5, 4, v5
    s_lshl_b32 s25, s20, 4
    v_add_u32 v3, s25, v3
    v_mul_u32_u24 v1, 1280, v3
    v_add_u32 v1, v1, v5
    v_lshrrev_b32 v3, 4, v0
    v_and_b32 v4, 15, v0
    v_lshlrev_b32 v5, 2, v3
    v_xor_b32 v4, v4, v5
    v_mov_b32 v5, 0
    v_cmp_le_u32 vcc, 5, v4
    v_mov_b32 v6, 1200
    s_nop 0
    v_cndmask_b32 v5, v5, v6, vcc
    v_cmp_le_u32 vcc, 10, v4
    v_mov_b32 v6, 2400
    s_nop 0
    v_cndmask_b32 v5, v5, v6, vcc
    v_cmp_le_u32 vcc, 15, v4
    v_mov_b32 v6, -240
    s_nop 0
    v_cndmask_b32 v5, v5, v6, vcc
    v_lshlrev_b32 v4, 4, v4
    v_add_u32 v4, v4, v5
    s_lshl_b32 s25, s20, 3
    v_add_u32 v3, s25, v3
    v_mul_u32_u24 v2, 3840, v3
    v_add_u32 v2, v2, v4
    v_add_u32 v8, 81920, v1
    v_add_u32 v9, 14336, v2
    s_mov_b32 s68, 122880
    s_mov_b32 s69, -2334720
    s_mov_b32 s58, s59
    s_mul_i32 s29, s59, 64
    s_add_u32 s21, s21, s29
    s_mul_i32 s29, s59, 122880
    s_add_u32 s22, s22, s29
    s_lshl_b32 s27, s20, 10
    s_lshl_b32 s28, s20, 11
    s_add_u32 m0, s27, 0
    s_add_u32 s58, s58, 1
    buffer_load_dwordx4 v1, s[8:11], s21 offen lds
    s_add_u32 m0, s27, 4096
    s_cmp_eq_u32 s58, 20
    buffer_load_dwordx4 v8, s[8:11], s21 offen lds
    s_cselect_b32 s29, -1216, 64
    s_add_u32 m0, s28, 40960
    s_add_u32 s21, s21, s29
    buffer_load_dwordx4 v2, s[12:15], s22 offen lds
    buffer_load_dwordx4 v9, s[12:15], s22 offen offset:1024 lds
    s_cmp_eq_u32 s58, 20
    s_cselect_b32 s29, s69, s68
    s_add_u32 s22, s22, s29
    s_add_u32 m0, s27, 8192
    s_add_u32 s58, s58, 1
    buffer_load_dwordx4 v1, s[8:11], s21 offen lds
    s_add_u32 m0, s27, 12288
    s_cmp_eq_u32 s58, 20
    buffer_load_dwordx4 v8, s[8:11], s21 offen lds
    s_cselect_b32 s29, -1216, 64
    s_add_u32 m0, s28, 49152
    s_add_u32 s21, s21, s29
    buffer_load_dwordx4 v2, s[12:15], s22 offen lds
    buffer_load_dwordx4 v9, s[12:15], s22 offen offset:1024 lds
    s_cmp_eq_u32 s58, 20
    s_cselect_b32 s29, s69, s68
    s_add_u32 s22, s22, s29
    s_add_u32 m0, s27, 16384
    s_add_u32 s58, s58, 1
    buffer_load_dwordx4 v1, s[8:11], s21 offen lds
    s_add_u32 m0, s27, 20480
    s_cmp_eq_u32 s58, 20
    buffer_load_dwordx4 v8, s[8:11], s21 offen lds
    s_cselect_b32 s29, -1216, 64
    s_add_u32 m0, s28, 57344
    s_add_u32 s21, s21, s29
    buffer_load_dwordx4 v2, s[12:15], s22 offen lds
    buffer_load_dwordx4 v9, s[12:15], s22 offen offset:1024 lds
    s_cmp_eq_u32 s58, 20
    s_cselect_b32 s29, s69, s68
    s_add_u32 s22, s22, s29
    s_waitcnt vmcnt(8)
    s_barrier
    s_add_u32 m0, s27, 24576
    s_add_u32 s58, s58, 1
    buffer_load_dwordx4 v1, s[8:11], s21 offen lds
    s_add_u32 m0, s27, 28672
    s_cmp_eq_u32 s58, 20
    buffer_load_dwordx4 v8, s[8:11], s21 offen lds
    s_cselect_b32 s29, -1216, 64
    s_add_u32 m0, s28, 65536
    s_add_u32 s21, s21, s29
    buffer_load_dwordx4 v2, s[12:15], s22 offen lds
    buffer_load_dwordx4 v9, s[12:15], s22 offen offset:1024 lds
    s_cmp_eq_u32 s58, 20
    s_cselect_b32 s29, s69, s68
    s_add_u32 s22, s22, s29
    s_waitcnt vmcnt(8)
    s_barrier
    s_add_u32 m0, s27, 32768
    s_add_u32 s58, s58, 1
    buffer_load_dwordx4 v1, s[8:11], s21 offen lds
    s_add_u32 m0, s27, 36864
    s_cmp_eq_u32 s58, 20
    buffer_load_dwordx4 v8, s[8:11], s21 offen lds
    s_cselect_b32 s29, -1216, 64
    s_add_u32 m0, s28, 73728
    s_add_u32 s21, s21, s29
    buffer_load_dwordx4 v2, s[12:15], s22 offen lds
    buffer_load_dwordx4 v9, s[12:15], s22 offen offset:1024 lds
    s_cmp_eq_u32 s58, 20
    s_cselect_b32 s29, s69, s68
    s_add_u32 s22, s22, s29
    s_waitcnt vmcnt(8)
    s_barrier
    s_add_u32 m0, s27, 0
    s_add_u32 s58, s58, 1
    buffer_load_dwordx4 v1, s[8:11], s21 offen lds
    s_add_u32 m0, s27, 4096
    s_cmp_eq_u32 s58, 20
    buffer_load_dwordx4 v8, s[8:11], s21 offen lds
    s_cselect_b32 s29, -1216, 64
    s_add_u32 m0, s28, 40960
    s_add_u32 s21, s21, s29
    buffer_load_dwordx4 v2, s[12:15], s22 offen lds
    buffer_load_dwordx4 v9, s[12:15], s22 offen offset:1024 lds
    s_cmp_eq_u32 s58, 20
    s_cselect_b32 s29, s69, s68
    s_add_u32 s22, s22, s29
    s_waitcnt vmcnt(8)
    s_barrier
    s_add_u32 m0, s27, 8192
    s_add_u32 s58, s58, 1
    buffer_load_dwordx4 v1, s[8:11], s21 offen lds
    s_add_u32 m0, s27, 12288
    s_cmp_eq_u32 s58, 20
    buffer_load_dwordx4 v8, s[8:11], s21 offen lds
    s_cselect_b32 s29, -1216, 64
    s_add_u32 m0, s28, 49152
    s_add_u32 s21, s21, s29
    buffer_load_dwordx4 v2, s[12:15], s22 offen lds
    buffer_load_dwordx4 v9, s[12:15], s22 offen offset:1024 lds
    s_cmp_eq_u32 s58, 20
    s_cselect_b32 s29, s69, s68
    s_add_u32 s22, s22, s29
    s_waitcnt vmcnt(8)
    s_barrier
    s_add_u32 m0, s27, 16384
    s_add_u32 s58, s58, 1
    buffer_load_dwordx4 v1, s[8:11], s21 offen lds
    s_add_u32 m0, s27, 20480
    s_cmp_eq_u32 s58, 20
    buffer_load_dwordx4 v8, s[8:11], s21 offen lds
    s_cselect_b32 s29, -1216, 64
    s_add_u32 m0, s28, 57344
    s_add_u32 s21, s21, s29
    buffer_load_dwordx4 v2, s[12:15], s22 offen lds
    buffer_load_dwordx4 v9, s[12:15], s22 offen offset:1024 lds
    s_cmp_eq_u32 s58, 20
    s_cselect_b32 s29, s69, s68
    s_add_u32 s22, s22, s29
    s_waitcnt vmcnt(8)
    s_barrier
    s_add_u32 m0, s27, 24576
    s_add_u32 s58, s58, 1
    buffer_load_dwordx4 v1, s[8:11], s21 offen lds
    s_add_u32 m0, s27, 28672
    s_cmp_eq_u32 s58, 20
    buffer_load_dwordx4 v8, s[8:11], s21 offen lds
    s_cselect_b32 s29, -1216, 64
    s_add_u32 m0, s28, 65536
    s_add_u32 s21, s21, s29
    buffer_load_dwordx4 v2, s[12:15], s22 offen lds
    buffer_load_dwordx4 v9, s[12:15], s22 offen offset:1024 lds
    s_cmp_eq_u32 s58, 20
    s_cselect_b32 s29, s69, s68
    s_add_u32 s22, s22, s29
    s_waitcnt vmcnt(8)
    s_barrier
    s_add_u32 m0, s27, 32768
    s_add_u32 s58, s58, 1
    buffer_load_dwordx4 v1, s[8:11], s21 offen lds
    s_add_u32 m0, s27, 36864
    s_cmp_eq_u32 s58, 20
    buffer_load_dwordx4 v8, s[8:11], s21 offen lds
    s_cselect_b32 s29, -1216, 64
    s_add_u32 m0, s28, 73728
    s_add_u32 s21, s21, s29
    buffer_load_dwordx4 v2, s[12:15], s22 offen lds
    buffer_load_dwordx4 v9, s[12:15], s22 offen offset:1024 lds
    s_cmp_eq_u32 s58, 20
    s_cselect_b32 s29, s69, s68
    s_add_u32 s22, s22, s29
    s_waitcnt vmcnt(8)
    s_barrier
    s_add_u32 m0, s27, 0
    s_add_u32 s58, s58, 1
    buffer_load_dwordx4 v1, s[8:11], s21 offen lds
    s_add_u32 m0, s27, 4096
    s_cmp_eq_u32 s58, 20
    buffer_load_dwordx4 v8, s[8:11], s21 offen lds
    s_cselect_b32 s29, -1216, 64
    s_add_u32 m0, s28, 40960
    s_add_u32 s21, s21, s29
    buffer_load_dwordx4 v2, s[12:15], s22 offen lds
    buffer_load_dwordx4 v9, s[12:15], s22 offen offset:1024 lds
    s_cmp_eq_u32 s58, 20
    s_cselect_b32 s29, s69, s68
    s_add_u32 s22, s22, s29
    s_waitcnt vmcnt(8)
    s_barrier
    s_add_u32 m0, s27, 8192
    s_add_u32 s58, s58, 1
    buffer_load_dwordx4 v1, s[8:11], s21 offen lds
    s_add_u32 m0, s27, 12288
    s_cmp_eq_u32 s58, 20
    buffer_load_dwordx4 v8, s[8:11], s21 offen lds
    s_cselect_b32 s29, -1216, 64
    s_add_u32 m0, s28, 49152
    s_add_u32 s21, s21, s29
    buffer_load_dwordx4 v2, s[12:15], s22 offen lds
    buffer_load_dwordx4 v9, s[12:15], s22 offen offset:1024 lds
    s_cmp_eq_u32 s58, 20
    s_cselect_b32 s29, s69, s68
    s_add_u32 s22, s22, s29
    s_waitcnt vmcnt(8)
    s_barrier
    s_add_u32 m0, s27, 16384
    s_add_u32 s58, s58, 1
    buffer_load_dwordx4 v1, s[8:11], s21 offen lds
    s_add_u32 m0, s27, 20480
    s_cmp_eq_u32 s58, 20
    buffer_load_dwordx4 v8, s[8:11], s21 offen lds
    s_cselect_b32 s29, -1216, 64
    s_add_u32 m0, s28, 57344
    s_add_u32 s21, s21, s29
    buffer_load_dwordx4 v2, s[12:15], s22 offen lds
    buffer_load_dwordx4 v9, s[12:15], s22 offen offset:1024 lds
    s_cmp_eq_u32 s58, 20
    s_cselect_b32 s29, s69, s68
    s_add_u32 s22, s22, s29
    s_waitcnt vmcnt(8)
    s_barrier
    s_add_u32 m0, s27, 24576
    s_add_u32 s58, s58, 1
    buffer_load_dwordx4 v1, s[8:11], s21 offen lds
    s_add_u32 m0, s27, 28672
    s_cmp_eq_u32 s58, 20
    buffer_load_dwordx4 v8, s[8:11], s21 offen lds
    s_cselect_b32 s29, -1216, 64
    s_add_u32 m0, s28, 65536
    s_add_u32 s21, s21, s29
    buffer_load_dwordx4 v2, s[12:15], s22 offen lds
    buffer_load_dwordx4 v9, s[12:15], s22 offen offset:1024 lds
    s_cmp_eq_u32 s58, 20
    s_cselect_b32 s29, s69, s68
    s_add_u32 s22, s22, s29
    s_waitcnt vmcnt(8)
    s_barrier
    s_add_u32 m0, s27, 32768
    s_add_u32 s58, s58, 1
    buffer_load_dwordx4 v1, s[8:11], s21 offen lds
    s_add_u32 m0, s27, 36864
    s_cmp_eq_u32 s58, 20
    buffer_load_dwordx4 v8, s[8:11], s21 offen lds
    s_cselect_b32 s29, -1216, 64
    s_add_u32 m0, s28, 73728
    s_add_u32 s21, s21, s29
    buffer_load_dwordx4 v2, s[12:15], s22 offen lds
    buffer_load_dwordx4 v9, s[12:15], s22 offen offset:1024 lds
    s_cmp_eq_u32 s58, 20
    s_cselect_b32 s29, s69, s68
    s_add_u32 s22, s22, s29
    s_waitcnt vmcnt(8)
    s_barrier
    s_add_u32 m0, s27, 0
    s_add_u32 s58, s58, 1
    buffer_load_dwordx4 v1, s[8:11], s21 offen lds
    s_add_u32 m0, s27, 4096
    s_cmp_eq_u32 s58, 20
    buffer_load_dwordx4 v8, s[8:11], s21 offen lds
    s_cselect_b32 s29, -1216, 64
    s_add_u32 m0, s28, 40960
    s_add_u32 s21, s21, s29
    buffer_load_dwordx4 v2, s[12:15], s22 offen lds
    buffer_load_dwordx4 v9, s[12:15], s22 offen offset:1024 lds
    s_cmp_eq_u32 s58, 20
    s_cselect_b32 s29, s69, s68
    s_add_u32 s22, s22, s29
    s_waitcnt vmcnt(8)
    s_barrier
    s_add_u32 m0, s27, 8192
    s_add_u32 s58, s58, 1
    buffer_load_dwordx4 v1, s[8:11], s21 offen lds
    s_add_u32 m0, s27, 12288
    s_cmp_eq_u32 s58, 20
    buffer_load_dwordx4 v8, s[8:11], s21 offen lds
    s_cselect_b32 s29, -1216, 64
    s_add_u32 m0, s28, 49152
    s_add_u32 s21, s21, s29
    buffer_load_dwordx4 v2, s[12:15], s22 offen lds
    buffer_load_dwordx4 v9, s[12:15], s22 offen offset:1024 lds
    s_cmp_eq_u32 s58, 20
    s_cselect_b32 s29, s69, s68
    s_add_u32 s22, s22, s29
    s_waitcnt vmcnt(8)
    s_barrier
    s_add_u32 m0, s27, 16384
    s_add_u32 s58, s58, 1
    buffer_load_dwordx4 v1, s[8:11], s21 offen lds
    s_add_u32 m0, s27, 20480
    s_cmp_eq_u32 s58, 20
    buffer_load_dwordx4 v8, s[8:11], s21 offen lds
    s_cselect_b32 s29, -1216, 64
    s_add_u32 m0, s28, 57344
    s_add_u32 s21, s21, s29
    buffer_load_dwordx4 v2, s[12:15], s22 offen lds
    buffer_load_dwordx4 v9, s[12:15], s22 offen offset:1024 lds
    s_cmp_eq_u32 s58, 20
    s_cselect_b32 s29, s69, s68
    s_add_u32 s22, s22, s29
    s_waitcnt vmcnt(8)
    s_barrier
    s_add_u32 m0, s27, 24576
    s_add_u32 s58, s58, 1
    buffer_load_dwordx4 v1, s[8:11], s21 offen lds
    s_add_u32 m0, s27, 28672
    s_cmp_eq_u32 s58, 20
    buffer_load_dwordx4 v8, s[8:11], s21 offen lds
    s_cselect_b32 s29, -1216, 64
    s_add_u32 m0, s28, 65536
    s_add_u32 s21, s21, s29
    buffer_load_dwordx4 v2, s[12:15], s22 offen lds
    buffer_load_dwordx4 v9, s[12:15], s22 offen offset:1024 lds
    s_cmp_eq_u32 s58, 20
    s_cselect_b32 s29, s69, s68
    s_add_u32 s22, s22, s29
    s_waitcnt vmcnt(8)
    s_barrier
    s_add_u32 m0, s27, 32768
    s_add_u32 s58, s58, 1
    buffer_load_dwordx4 v1, s[8:11], s21 offen lds
    s_add_u32 m0, s27, 36864
    s_cmp_eq_u32 s58, 20
    buffer_load_dwordx4 v8, s[8:11], s21 offen lds
    s_cselect_b32 s29, -1216, 64
    s_add_u32 m0, s28, 73728
    s_add_u32 s21, s21, s29
    buffer_load_dwordx4 v2, s[12:15], s22 offen lds
    buffer_load_dwordx4 v9, s[12:15], s22 offen offset:1024 lds
    s_cmp_eq_u32 s58, 20
    s_cselect_b32 s29, s69, s68
    s_add_u32 s22, s22, s29
    s_waitcnt vmcnt(8)
    s_barrier
    s_waitcnt vmcnt(4)
    s_barrier
    s_waitcnt vmcnt(0)
    s_barrier
    s_bitcmp0_b32 s2, 3
    s_cbranch_scc1 L_ald_exit_2021
    s_barrier
    s_barrier
    s_barrier
    s_barrier
    s_barrier
    s_mov_b32 s42, 0
    s_branch L_out_loader_shared
L_ald_exit_2021:
    s_endpgm
L_compute_2020:
    v_and_b32 v12, 31, v0
    v_lshrrev_b32 v13, 5, v0
    v_subrev_u32 v14, 2, v12
    v_cmp_le_u32 vcc, 20, v12
    s_nop 1
    v_cndmask_b32 v14, v12, v14, vcc
    v_lshlrev_b32 v14, 1, v14
    v_and_b32 v15, 30, v12
    v_cmp_eq_u32 vcc, 18, v15
    v_cmp_le_u32 s[26:27], 22, v12
    s_nop 1
    s_or_b64 vcc, vcc, s[26:27]
    v_mov_b32 v15, 0x20000
    s_nop 1
    v_cndmask_b32 v14, v14, v15, vcc
    v_mul_u32_u24 v15, 160, v13
    v_add_u32 v12, v14, v15
    s_mul_i32 s25, s41, 1600
    buffer_load_ushort v64, v12, s[44:47], s25 offen offset:0
    buffer_load_ushort v65, v12, s[44:47], s25 offen offset:40
    buffer_load_ushort v66, v12, s[44:47], s25 offen offset:80
    buffer_load_ushort v67, v12, s[44:47], s25 offen offset:120
    buffer_load_ushort v68, v12, s[44:47], s25 offen offset:320
    buffer_load_ushort v69, v12, s[44:47], s25 offen offset:360
    buffer_load_ushort v70, v12, s[44:47], s25 offen offset:400
    buffer_load_ushort v71, v12, s[44:47], s25 offen offset:440
    buffer_load_ushort v72, v12, s[44:47], s25 offen offset:960
    buffer_load_ushort v73, v12, s[44:47], s25 offen offset:1000
    buffer_load_ushort v74, v12, s[44:47], s25 offen offset:1040
    buffer_load_ushort v75, v12, s[44:47], s25 offen offset:1080
    buffer_load_ushort v76, v12, s[44:47], s25 offen offset:1280
    buffer_load_ushort v77, v12, s[44:47], s25 offen offset:1320
    buffer_load_ushort v78, v12, s[44:47], s25 offen offset:1360
    buffer_load_ushort v79, v12, s[44:47], s25 offen offset:1400
    v_cmp_eq_u32 vcc, 0, v13
    v_mov_b32 v15, 0x20000
    s_nop 0
    v_cndmask_b32 v12, v15, v14, vcc
    v_cndmask_b32 v13, v14, v15, vcc
    buffer_load_ushort v80, v12, s[44:47], s25 offen offset:640
    buffer_load_ushort v81, v12, s[44:47], s25 offen offset:680
    buffer_load_ushort v82, v12, s[44:47], s25 offen offset:720
    buffer_load_ushort v83, v12, s[44:47], s25 offen offset:760
    buffer_load_ushort v84, v13, s[44:47], s25 offen offset:800
    buffer_load_ushort v85, v13, s[44:47], s25 offen offset:840
    buffer_load_ushort v86, v13, s[44:47], s25 offen offset:880
    buffer_load_ushort v87, v13, s[44:47], s25 offen offset:920
    s_waitcnt vmcnt(0)
    v_lshl_or_b32 v52, v65, 16, v64
    v_lshl_or_b32 v53, v67, 16, v66
    v_lshl_or_b32 v54, v69, 16, v68
    v_lshl_or_b32 v55, v71, 16, v70
    v_lshl_or_b32 v56, v73, 16, v72
    v_lshl_or_b32 v57, v75, 16, v74
    v_lshl_or_b32 v58, v77, 16, v76
    v_lshl_or_b32 v59, v79, 16, v78
    v_lshl_or_b32 v60, v81, 16, v80
    v_lshl_or_b32 v61, v83, 16, v82
    v_lshl_or_b32 v62, v85, 16, v84
    v_lshl_or_b32 v63, v87, 16, v86
    v_and_b32 v12, 31, v0
    s_lshl_b32 s25, s20, 5
    v_add_u32 v12, s25, v12
    v_bfe_u32 v13, v12, 2, 2
    v_lshrrev_b32 v14, 5, v0
    v_xor_b32 v13, v13, v14
    v_lshlrev_b32 v13, 4, v13
    v_lshlrev_b32 v12, 6, v12
    v_add_u32 v1, v12, v13
    v_xor_b32 v2, 32, v1
    v_bfe_u32 v12, v0, 2, 2
    v_lshrrev_b32 v13, 5, v0
    v_lshlrev_b32 v13, 3, v13
    v_add_u32 v13, v13, v12
    v_mul_u32_u24 v13, 256, v13
    v_bfe_u32 v14, v0, 4, 1
    v_lshlrev_b32 v14, 5, v14
    v_add_u32 v13, v13, v14
    v_and_b32 v14, 3, v0
    v_lshlrev_b32 v14, 3, v14
    v_add_u32 v13, v13, v14
    v_add_u32 v13, 40960, v13
    v_xor_b32 v14, 0, v12
    v_lshlrev_b32 v14, 6, v14
    v_add_u32 v3, v13, v14
    v_xor_b32 v14, 1, v12
    v_lshlrev_b32 v14, 6, v14
    v_add_u32 v4, v13, v14
    v_xor_b32 v14, 2, v12
    v_lshlrev_b32 v14, 6, v14
    v_add_u32 v5, v13, v14
    v_xor_b32 v14, 3, v12
    v_lshlrev_b32 v14, 6, v14
    v_add_u32 v6, v13, v14
    v_mov_b32 v64, 0
    v_mov_b32 v65, 0
    v_mov_b32 v66, 0
    v_mov_b32 v67, 0
    v_mov_b32 v68, 0
    v_mov_b32 v69, 0
    v_mov_b32 v70, 0
    v_mov_b32 v71, 0
    v_mov_b32 v72, 0
    v_mov_b32 v73, 0
    v_mov_b32 v74, 0
    v_mov_b32 v75, 0
    v_mov_b32 v76, 0
    v_mov_b32 v77, 0
    v_mov_b32 v78, 0
    v_mov_b32 v79, 0
    v_mov_b32 v80, 0
    v_mov_b32 v81, 0
    v_mov_b32 v82, 0
    v_mov_b32 v83, 0
    v_mov_b32 v84, 0
    v_mov_b32 v85, 0
    v_mov_b32 v86, 0
    v_mov_b32 v87, 0
    v_mov_b32 v88, 0
    v_mov_b32 v89, 0
    v_mov_b32 v90, 0
    v_mov_b32 v91, 0
    v_mov_b32 v92, 0
    v_mov_b32 v93, 0
    v_mov_b32 v94, 0
    v_mov_b32 v95, 0
    v_mov_b32 v96, 0
    v_mov_b32 v97, 0
    v_mov_b32 v98, 0
    v_mov_b32 v99, 0
    v_mov_b32 v100, 0
    v_mov_b32 v101, 0
    v_mov_b32 v102, 0
    v_mov_b32 v103, 0
    v_mov_b32 v104, 0
    v_mov_b32 v105, 0
    v_mov_b32 v106, 0
    v_mov_b32 v107, 0
    v_mov_b32 v108, 0
    v_mov_b32 v109, 0
    v_mov_b32 v110, 0
    v_mov_b32 v111, 0
    v_mov_b32 v112, 0
    v_mov_b32 v113, 0
    v_mov_b32 v114, 0
    v_mov_b32 v115, 0
    v_mov_b32 v116, 0
    v_mov_b32 v117, 0
    v_mov_b32 v118, 0
    v_mov_b32 v119, 0
    v_mov_b32 v120, 0
    v_mov_b32 v121, 0
    v_mov_b32 v122, 0
    v_mov_b32 v123, 0
    v_mov_b32 v124, 0
    v_mov_b32 v125, 0
    v_mov_b32 v126, 0
    v_mov_b32 v127, 0
    s_mov_b32 s24, 0
L_gp_loop_2022:
    s_barrier
    ds_read_b128 v[8:11], v1 offset:0
    ds_read_b64_tr_b16 v[16:17], v3 offset:0
    ds_read_b64_tr_b16 v[18:19], v3 offset:1024
    s_waitcnt lgkmcnt(0)
    ds_read_b64_tr_b16 v[20:21], v4 offset:0
    ds_read_b64_tr_b16 v[22:23], v4 offset:1024
    v_mfma_f32_32x32x16_bf16 v[64:79], v[16:19], v[8:11], v[64:79]
    s_waitcnt lgkmcnt(0)
    ds_read_b64_tr_b16 v[24:25], v5 offset:0
    ds_read_b64_tr_b16 v[26:27], v5 offset:1024
    v_mfma_f32_32x32x16_bf16 v[80:95], v[20:23], v[8:11], v[80:95]
    s_waitcnt lgkmcnt(0)
    ds_read_b64_tr_b16 v[28:29], v6 offset:0
    ds_read_b64_tr_b16 v[30:31], v6 offset:1024
    v_mfma_f32_32x32x16_bf16 v[96:111], v[24:27], v[8:11], v[96:111]
    s_waitcnt lgkmcnt(0)
    v_mfma_f32_32x32x16_bf16 v[112:127], v[28:31], v[8:11], v[112:127]
    ds_read_b128 v[12:15], v2 offset:0
    ds_read_b64_tr_b16 v[32:33], v3 offset:4096
    ds_read_b64_tr_b16 v[34:35], v3 offset:5120
    s_waitcnt lgkmcnt(0)
    ds_read_b64_tr_b16 v[36:37], v4 offset:4096
    ds_read_b64_tr_b16 v[38:39], v4 offset:5120
    v_mfma_f32_32x32x16_bf16 v[64:79], v[32:35], v[12:15], v[64:79]
    s_waitcnt lgkmcnt(0)
    ds_read_b64_tr_b16 v[40:41], v5 offset:4096
    ds_read_b64_tr_b16 v[42:43], v5 offset:5120
    v_mfma_f32_32x32x16_bf16 v[80:95], v[36:39], v[12:15], v[80:95]
    s_waitcnt lgkmcnt(0)
    ds_read_b64_tr_b16 v[44:45], v6 offset:4096
    ds_read_b64_tr_b16 v[46:47], v6 offset:5120
    v_mfma_f32_32x32x16_bf16 v[96:111], v[40:43], v[12:15], v[96:111]
    s_waitcnt lgkmcnt(0)
    v_mfma_f32_32x32x16_bf16 v[112:127], v[44:47], v[12:15], v[112:127]
    s_barrier
    ds_read_b128 v[8:11], v1 offset:8192
    ds_read_b64_tr_b16 v[16:17], v3 offset:8192
    ds_read_b64_tr_b16 v[18:19], v3 offset:9216
    s_waitcnt lgkmcnt(0)
    ds_read_b64_tr_b16 v[20:21], v4 offset:8192
    ds_read_b64_tr_b16 v[22:23], v4 offset:9216
    v_mfma_f32_32x32x16_bf16 v[64:79], v[16:19], v[8:11], v[64:79]
    s_waitcnt lgkmcnt(0)
    ds_read_b64_tr_b16 v[24:25], v5 offset:8192
    ds_read_b64_tr_b16 v[26:27], v5 offset:9216
    v_mfma_f32_32x32x16_bf16 v[80:95], v[20:23], v[8:11], v[80:95]
    s_waitcnt lgkmcnt(0)
    ds_read_b64_tr_b16 v[28:29], v6 offset:8192
    ds_read_b64_tr_b16 v[30:31], v6 offset:9216
    v_mfma_f32_32x32x16_bf16 v[96:111], v[24:27], v[8:11], v[96:111]
    s_waitcnt lgkmcnt(0)
    v_mfma_f32_32x32x16_bf16 v[112:127], v[28:31], v[8:11], v[112:127]
    ds_read_b128 v[12:15], v2 offset:8192
    ds_read_b64_tr_b16 v[32:33], v3 offset:12288
    ds_read_b64_tr_b16 v[34:35], v3 offset:13312
    s_waitcnt lgkmcnt(0)
    ds_read_b64_tr_b16 v[36:37], v4 offset:12288
    ds_read_b64_tr_b16 v[38:39], v4 offset:13312
    v_mfma_f32_32x32x16_bf16 v[64:79], v[32:35], v[12:15], v[64:79]
    s_waitcnt lgkmcnt(0)
    ds_read_b64_tr_b16 v[40:41], v5 offset:12288
    ds_read_b64_tr_b16 v[42:43], v5 offset:13312
    v_mfma_f32_32x32x16_bf16 v[80:95], v[36:39], v[12:15], v[80:95]
    s_waitcnt lgkmcnt(0)
    ds_read_b64_tr_b16 v[44:45], v6 offset:12288
    ds_read_b64_tr_b16 v[46:47], v6 offset:13312
    v_mfma_f32_32x32x16_bf16 v[96:111], v[40:43], v[12:15], v[96:111]
    s_waitcnt lgkmcnt(0)
    v_mfma_f32_32x32x16_bf16 v[112:127], v[44:47], v[12:15], v[112:127]
    s_barrier
    ds_read_b128 v[8:11], v1 offset:16384
    ds_read_b64_tr_b16 v[16:17], v3 offset:16384
    ds_read_b64_tr_b16 v[18:19], v3 offset:17408
    s_waitcnt lgkmcnt(0)
    ds_read_b64_tr_b16 v[20:21], v4 offset:16384
    ds_read_b64_tr_b16 v[22:23], v4 offset:17408
    v_mfma_f32_32x32x16_bf16 v[64:79], v[16:19], v[8:11], v[64:79]
    s_waitcnt lgkmcnt(0)
    ds_read_b64_tr_b16 v[24:25], v5 offset:16384
    ds_read_b64_tr_b16 v[26:27], v5 offset:17408
    v_mfma_f32_32x32x16_bf16 v[80:95], v[20:23], v[8:11], v[80:95]
    s_waitcnt lgkmcnt(0)
    ds_read_b64_tr_b16 v[28:29], v6 offset:16384
    ds_read_b64_tr_b16 v[30:31], v6 offset:17408
    v_mfma_f32_32x32x16_bf16 v[96:111], v[24:27], v[8:11], v[96:111]
    s_waitcnt lgkmcnt(0)
    v_mfma_f32_32x32x16_bf16 v[112:127], v[28:31], v[8:11], v[112:127]
    ds_read_b128 v[12:15], v2 offset:16384
    ds_read_b64_tr_b16 v[32:33], v3 offset:20480
    ds_read_b64_tr_b16 v[34:35], v3 offset:21504
    s_waitcnt lgkmcnt(0)
    ds_read_b64_tr_b16 v[36:37], v4 offset:20480
    ds_read_b64_tr_b16 v[38:39], v4 offset:21504
    v_mfma_f32_32x32x16_bf16 v[64:79], v[32:35], v[12:15], v[64:79]
    s_waitcnt lgkmcnt(0)
    ds_read_b64_tr_b16 v[40:41], v5 offset:20480
    ds_read_b64_tr_b16 v[42:43], v5 offset:21504
    v_mfma_f32_32x32x16_bf16 v[80:95], v[36:39], v[12:15], v[80:95]
    s_waitcnt lgkmcnt(0)
    ds_read_b64_tr_b16 v[44:45], v6 offset:20480
    ds_read_b64_tr_b16 v[46:47], v6 offset:21504
    v_mfma_f32_32x32x16_bf16 v[96:111], v[40:43], v[12:15], v[96:111]
    s_waitcnt lgkmcnt(0)
    v_mfma_f32_32x32x16_bf16 v[112:127], v[44:47], v[12:15], v[112:127]
    s_barrier
    ds_read_b128 v[8:11], v1 offset:24576
    ds_read_b64_tr_b16 v[16:17], v3 offset:24576
    ds_read_b64_tr_b16 v[18:19], v3 offset:25600
    s_waitcnt lgkmcnt(0)
    ds_read_b64_tr_b16 v[20:21], v4 offset:24576
    ds_read_b64_tr_b16 v[22:23], v4 offset:25600
    v_mfma_f32_32x32x16_bf16 v[64:79], v[16:19], v[8:11], v[64:79]
    s_waitcnt lgkmcnt(0)
    ds_read_b64_tr_b16 v[24:25], v5 offset:24576
    ds_read_b64_tr_b16 v[26:27], v5 offset:25600
    v_mfma_f32_32x32x16_bf16 v[80:95], v[20:23], v[8:11], v[80:95]
    s_waitcnt lgkmcnt(0)
    ds_read_b64_tr_b16 v[28:29], v6 offset:24576
    ds_read_b64_tr_b16 v[30:31], v6 offset:25600
    v_mfma_f32_32x32x16_bf16 v[96:111], v[24:27], v[8:11], v[96:111]
    s_waitcnt lgkmcnt(0)
    v_mfma_f32_32x32x16_bf16 v[112:127], v[28:31], v[8:11], v[112:127]
    ds_read_b128 v[12:15], v2 offset:24576
    ds_read_b64_tr_b16 v[32:33], v3 offset:28672
    ds_read_b64_tr_b16 v[34:35], v3 offset:29696
    s_waitcnt lgkmcnt(0)
    ds_read_b64_tr_b16 v[36:37], v4 offset:28672
    ds_read_b64_tr_b16 v[38:39], v4 offset:29696
    v_mfma_f32_32x32x16_bf16 v[64:79], v[32:35], v[12:15], v[64:79]
    s_waitcnt lgkmcnt(0)
    ds_read_b64_tr_b16 v[40:41], v5 offset:28672
    ds_read_b64_tr_b16 v[42:43], v5 offset:29696
    v_mfma_f32_32x32x16_bf16 v[80:95], v[36:39], v[12:15], v[80:95]
    s_waitcnt lgkmcnt(0)
    ds_read_b64_tr_b16 v[44:45], v6 offset:28672
    ds_read_b64_tr_b16 v[46:47], v6 offset:29696
    v_mfma_f32_32x32x16_bf16 v[96:111], v[40:43], v[12:15], v[96:111]
    s_waitcnt lgkmcnt(0)
    v_mfma_f32_32x32x16_bf16 v[112:127], v[44:47], v[12:15], v[112:127]
    s_barrier
    ds_read_b128 v[8:11], v1 offset:32768
    ds_read_b64_tr_b16 v[16:17], v3 offset:32768
    ds_read_b64_tr_b16 v[18:19], v3 offset:33792
    s_waitcnt lgkmcnt(0)
    ds_read_b64_tr_b16 v[20:21], v4 offset:32768
    ds_read_b64_tr_b16 v[22:23], v4 offset:33792
    v_mfma_f32_32x32x16_bf16 v[64:79], v[16:19], v[8:11], v[64:79]
    s_waitcnt lgkmcnt(0)
    ds_read_b64_tr_b16 v[24:25], v5 offset:32768
    ds_read_b64_tr_b16 v[26:27], v5 offset:33792
    v_mfma_f32_32x32x16_bf16 v[80:95], v[20:23], v[8:11], v[80:95]
    s_waitcnt lgkmcnt(0)
    ds_read_b64_tr_b16 v[28:29], v6 offset:32768
    ds_read_b64_tr_b16 v[30:31], v6 offset:33792
    v_mfma_f32_32x32x16_bf16 v[96:111], v[24:27], v[8:11], v[96:111]
    s_waitcnt lgkmcnt(0)
    v_mfma_f32_32x32x16_bf16 v[112:127], v[28:31], v[8:11], v[112:127]
    ds_read_b128 v[12:15], v2 offset:32768
    ds_read_b64_tr_b16 v[32:33], v3 offset:36864
    ds_read_b64_tr_b16 v[34:35], v3 offset:37888
    s_waitcnt lgkmcnt(0)
    ds_read_b64_tr_b16 v[36:37], v4 offset:36864
    ds_read_b64_tr_b16 v[38:39], v4 offset:37888
    v_mfma_f32_32x32x16_bf16 v[64:79], v[32:35], v[12:15], v[64:79]
    s_waitcnt lgkmcnt(0)
    ds_read_b64_tr_b16 v[40:41], v5 offset:36864
    ds_read_b64_tr_b16 v[42:43], v5 offset:37888
    v_mfma_f32_32x32x16_bf16 v[80:95], v[36:39], v[12:15], v[80:95]
    s_waitcnt lgkmcnt(0)
    ds_read_b64_tr_b16 v[44:45], v6 offset:36864
    ds_read_b64_tr_b16 v[46:47], v6 offset:37888
    v_mfma_f32_32x32x16_bf16 v[96:111], v[40:43], v[12:15], v[96:111]
    s_waitcnt lgkmcnt(0)
    v_mfma_f32_32x32x16_bf16 v[112:127], v[44:47], v[12:15], v[112:127]
    s_add_u32 s24, s24, 5
    s_cmp_lt_u32 s24, 20
    s_cbranch_scc1 L_gp_loop_2022
    s_setprio 3
    s_nop 7
    s_nop 3
    v_cvt_pk_bf16_f32 v4, v64, v65
    v_cvt_pk_bf16_f32 v5, v66, v67
    v_cvt_pk_bf16_f32 v6, v68, v69
    v_cvt_pk_bf16_f32 v7, v70, v71
    v_cvt_pk_bf16_f32 v8, v72, v73
    v_cvt_pk_bf16_f32 v9, v74, v75
    v_cvt_pk_bf16_f32 v10, v76, v77
    v_cvt_pk_bf16_f32 v11, v78, v79
    v_cvt_pk_bf16_f32 v12, v80, v81
    v_cvt_pk_bf16_f32 v13, v82, v83
    v_cvt_pk_bf16_f32 v14, v84, v85
    v_cvt_pk_bf16_f32 v15, v86, v87
    v_cvt_pk_bf16_f32 v16, v88, v89
    v_cvt_pk_bf16_f32 v17, v90, v91
    v_cvt_pk_bf16_f32 v18, v92, v93
    v_cvt_pk_bf16_f32 v19, v94, v95
    v_cvt_pk_bf16_f32 v20, v96, v97
    v_cvt_pk_bf16_f32 v21, v98, v99
    v_cvt_pk_bf16_f32 v22, v100, v101
    v_cvt_pk_bf16_f32 v23, v102, v103
    v_cvt_pk_bf16_f32 v24, v104, v105
    v_cvt_pk_bf16_f32 v25, v106, v107
    v_cvt_pk_bf16_f32 v26, v108, v109
    v_cvt_pk_bf16_f32 v27, v110, v111
    v_cvt_pk_bf16_f32 v28, v112, v113
    v_cvt_pk_bf16_f32 v29, v114, v115
    v_cvt_pk_bf16_f32 v30, v116, v117
    v_cvt_pk_bf16_f32 v31, v118, v119
    v_cvt_pk_bf16_f32 v32, v120, v121
    v_cvt_pk_bf16_f32 v33, v122, v123
    s_barrier
    v_and_b32 v34, 31, v0
    s_lshl_b32 s25, s20, 5
    v_add_u32 v34, s25, v34
    v_bfe_u32 v35, v34, 1, 3
    v_lshlrev_b32 v34, 6, v34
    v_lshrrev_b32 v36, 5, v0
    v_add_u32 v38, 0, v36
    v_xor_b32 v38, v38, v35
    v_lshl_add_u32 v38, v38, 3, v34
    v_add_u32 v39, 2, v36
    v_xor_b32 v39, v39, v35
    v_lshl_add_u32 v39, v39, 3, v34
    v_mul_i32_i24 v40, 0, v36
    v_add_u32 v40, 4, v40
    v_xor_b32 v40, v40, v35
    v_lshl_add_u32 v40, v40, 3, v34
    v_mul_i32_i24 v37, 4, v36
    v_add_u32 v40, v40, v37
    v_mfma_f32_32x32x16_bf16 v[64:79], v[52:55], v[14:17], 0
    v_mfma_f32_32x32x8_bf16 v[64:79], v[60:61], v[18:19], v[64:79]
    s_nop 7
    s_nop 4
    v_max3_f32 v92, v64, v65, v66
    v_min3_f32 v93, v64, v65, v66
    v_max3_f32 v92, v92, v67, v68
    v_min3_f32 v93, v93, v67, v68
    v_max3_f32 v92, v92, v69, v70
    v_min3_f32 v93, v93, v69, v70
    v_max3_f32 v92, v92, v71, v72
    v_min3_f32 v93, v93, v71, v72
    v_max_f32 v92, v92, v73
    v_min_f32 v93, v93, v73
    v_mov_b32 v94, v92
    v_mov_b32 v95, v93
    s_nop 1
    v_permlane32_swap_b32 v92, v94
    v_permlane32_swap_b32 v93, v95
    s_nop 1
    v_max_f32 v92, v92, v94
    v_min_f32 v93, v93, v95
    v_mul_f32 v92, s53, v92
    v_mul_f32 v93, s52, v93
    v_pk_fma_f32 v[80:81], v[64:65], s[86:87], v[92:93] op_sel:[0,0,1] op_sel_hi:[1,1,1]
    v_pk_fma_f32 v[64:65], v[64:65], s[100:101], v[92:93] op_sel:[0,0,0] op_sel_hi:[1,1,0]
    v_pk_fma_f32 v[82:83], v[66:67], s[86:87], v[92:93] op_sel:[0,0,1] op_sel_hi:[1,1,1]
    v_pk_fma_f32 v[66:67], v[66:67], s[100:101], v[92:93] op_sel:[0,0,0] op_sel_hi:[1,1,0]
    v_pk_fma_f32 v[84:85], v[68:69], s[86:87], v[92:93] op_sel:[0,0,1] op_sel_hi:[1,1,1]
    v_pk_fma_f32 v[68:69], v[68:69], s[100:101], v[92:93] op_sel:[0,0,0] op_sel_hi:[1,1,0]
    v_pk_fma_f32 v[86:87], v[70:71], s[86:87], v[92:93] op_sel:[0,0,1] op_sel_hi:[1,1,1]
    v_pk_fma_f32 v[70:71], v[70:71], s[100:101], v[92:93] op_sel:[0,0,0] op_sel_hi:[1,1,0]
    v_pk_fma_f32 v[88:89], v[72:73], s[86:87], v[92:93] op_sel:[0,0,1] op_sel_hi:[1,1,1]
    v_pk_fma_f32 v[72:73], v[72:73], s[100:101], v[92:93] op_sel:[0,0,0] op_sel_hi:[1,1,0]
    v_exp_f32 v64, v64
    v_exp_f32 v80, v80
    v_exp_f32 v65, v65
    v_exp_f32 v81, v81
    v_exp_f32 v66, v66
    v_exp_f32 v82, v82
    v_exp_f32 v67, v67
    v_exp_f32 v83, v83
    v_exp_f32 v68, v68
    v_exp_f32 v84, v84
    v_exp_f32 v69, v69
    v_exp_f32 v85, v85
    v_exp_f32 v70, v70
    v_exp_f32 v86, v86
    v_exp_f32 v71, v71
    v_exp_f32 v87, v87
    v_exp_f32 v72, v72
    v_exp_f32 v88, v88
    v_exp_f32 v73, v73
    v_exp_f32 v89, v89
    s_nop 0
    v_pk_add_f32 v[96:97], v[64:65], v[66:67]
    v_pk_add_f32 v[98:99], v[80:81], v[82:83]
    v_pk_add_f32 v[96:97], v[96:97], v[68:69]
    v_pk_add_f32 v[98:99], v[98:99], v[84:85]
    v_pk_add_f32 v[96:97], v[96:97], v[70:71]
    v_pk_add_f32 v[98:99], v[98:99], v[86:87]
    v_pk_add_f32 v[96:97], v[96:97], v[72:73]
    v_pk_add_f32 v[98:99], v[98:99], v[88:89]
    v_add_f32 v96, v96, v97
    v_add_f32 v98, v98, v99
    v_mov_b32 v94, v96
    v_mov_b32 v95, v98
    s_nop 1
    v_permlane32_swap_b32 v96, v94
    v_permlane32_swap_b32 v98, v95
    s_nop 1
    v_add_f32 v96, v96, v94
    v_add_f32 v98, v98, v95
    v_rcp_f32 v96, v96
    v_rcp_f32 v98, v98
    s_nop 0
    v_pk_mul_f32 v[64:65], v[64:65], v[96:97] op_sel:[0,0] op_sel_hi:[1,0]
    v_pk_mul_f32 v[80:81], v[80:81], v[98:99] op_sel:[0,0] op_sel_hi:[1,0]
    v_pk_mul_f32 v[66:67], v[66:67], v[96:97] op_sel:[0,0] op_sel_hi:[1,0]
    v_pk_mul_f32 v[82:83], v[82:83], v[98:99] op_sel:[0,0] op_sel_hi:[1,0]
    v_pk_mul_f32 v[68:69], v[68:69], v[96:97] op_sel:[0,0] op_sel_hi:[1,0]
    v_pk_mul_f32 v[84:85], v[84:85], v[98:99] op_sel:[0,0] op_sel_hi:[1,0]
    v_pk_mul_f32 v[70:71], v[70:71], v[96:97] op_sel:[0,0] op_sel_hi:[1,0]
    v_pk_mul_f32 v[86:87], v[86:87], v[98:99] op_sel:[0,0] op_sel_hi:[1,0]
    v_pk_mul_f32 v[72:73], v[72:73], v[96:97] op_sel:[0,0] op_sel_hi:[1,0]
    v_pk_mul_f32 v[88:89], v[88:89], v[98:99] op_sel:[0,0] op_sel_hi:[1,0]
    v_cvt_pk_bf16_f32 v100, v64, v65
    v_cvt_pk_bf16_f32 v106, v80, v81
    v_cvt_pk_bf16_f32 v101, v66, v67
    v_cvt_pk_bf16_f32 v107, v82, v83
    v_cvt_pk_bf16_f32 v102, v68, v69
    v_cvt_pk_bf16_f32 v108, v84, v85
    v_cvt_pk_bf16_f32 v103, v70, v71
    v_cvt_pk_bf16_f32 v109, v86, v87
    v_cvt_pk_bf16_f32 v104, v72, v73
    v_cvt_pk_bf16_f32 v110, v88, v89
    ds_write_b64 v38, v[100:101] offset:0
    ds_write_b64 v39, v[102:103] offset:0
    ds_write_b32 v40, v104 offset:0
    ds_write_b64 v38, v[106:107] offset:8192
    ds_write_b64 v39, v[108:109] offset:8192
    ds_write_b32 v40, v110 offset:8192
    v_mfma_f32_32x32x16_bf16 v[64:79], v[56:59], v[20:23], 0
    v_mfma_f32_32x32x8_bf16 v[64:79], v[62:63], v[18:19], v[64:79]
    s_nop 7
    s_nop 4
    v_max3_f32 v92, v64, v65, v66
    v_min3_f32 v93, v64, v65, v66
    v_max3_f32 v92, v92, v67, v68
    v_min3_f32 v93, v93, v67, v68
    v_max3_f32 v92, v92, v69, v70
    v_min3_f32 v93, v93, v69, v70
    v_max3_f32 v92, v92, v71, v72
    v_min3_f32 v93, v93, v71, v72
    v_max_f32 v92, v92, v73
    v_min_f32 v93, v93, v73
    v_mov_b32 v94, v92
    v_mov_b32 v95, v93
    s_nop 1
    v_permlane32_swap_b32 v92, v94
    v_permlane32_swap_b32 v93, v95
    s_nop 1
    v_max_f32 v92, v92, v94
    v_min_f32 v93, v93, v95
    v_mul_f32 v92, s53, v92
    v_mul_f32 v93, s52, v93
    v_pk_fma_f32 v[80:81], v[64:65], s[86:87], v[92:93] op_sel:[0,0,1] op_sel_hi:[1,1,1]
    v_pk_fma_f32 v[64:65], v[64:65], s[100:101], v[92:93] op_sel:[0,0,0] op_sel_hi:[1,1,0]
    v_pk_fma_f32 v[82:83], v[66:67], s[86:87], v[92:93] op_sel:[0,0,1] op_sel_hi:[1,1,1]
    v_pk_fma_f32 v[66:67], v[66:67], s[100:101], v[92:93] op_sel:[0,0,0] op_sel_hi:[1,1,0]
    v_pk_fma_f32 v[84:85], v[68:69], s[86:87], v[92:93] op_sel:[0,0,1] op_sel_hi:[1,1,1]
    v_pk_fma_f32 v[68:69], v[68:69], s[100:101], v[92:93] op_sel:[0,0,0] op_sel_hi:[1,1,0]
    v_pk_fma_f32 v[86:87], v[70:71], s[86:87], v[92:93] op_sel:[0,0,1] op_sel_hi:[1,1,1]
    v_pk_fma_f32 v[70:71], v[70:71], s[100:101], v[92:93] op_sel:[0,0,0] op_sel_hi:[1,1,0]
    v_pk_fma_f32 v[88:89], v[72:73], s[86:87], v[92:93] op_sel:[0,0,1] op_sel_hi:[1,1,1]
    v_pk_fma_f32 v[72:73], v[72:73], s[100:101], v[92:93] op_sel:[0,0,0] op_sel_hi:[1,1,0]
    v_exp_f32 v64, v64
    v_exp_f32 v80, v80
    v_exp_f32 v65, v65
    v_exp_f32 v81, v81
    v_exp_f32 v66, v66
    v_exp_f32 v82, v82
    v_exp_f32 v67, v67
    v_exp_f32 v83, v83
    v_exp_f32 v68, v68
    v_exp_f32 v84, v84
    v_exp_f32 v69, v69
    v_exp_f32 v85, v85
    v_exp_f32 v70, v70
    v_exp_f32 v86, v86
    v_exp_f32 v71, v71
    v_exp_f32 v87, v87
    v_exp_f32 v72, v72
    v_exp_f32 v88, v88
    v_exp_f32 v73, v73
    v_exp_f32 v89, v89
    s_nop 0
    v_pk_add_f32 v[96:97], v[64:65], v[66:67]
    v_pk_add_f32 v[98:99], v[80:81], v[82:83]
    v_pk_add_f32 v[96:97], v[96:97], v[68:69]
    v_pk_add_f32 v[98:99], v[98:99], v[84:85]
    v_pk_add_f32 v[96:97], v[96:97], v[70:71]
    v_pk_add_f32 v[98:99], v[98:99], v[86:87]
    v_pk_add_f32 v[96:97], v[96:97], v[72:73]
    v_pk_add_f32 v[98:99], v[98:99], v[88:89]
    v_add_f32 v96, v96, v97
    v_add_f32 v98, v98, v99
    v_mov_b32 v94, v96
    v_mov_b32 v95, v98
    s_nop 1
    v_permlane32_swap_b32 v96, v94
    v_permlane32_swap_b32 v98, v95
    s_nop 1
    v_add_f32 v96, v96, v94
    v_add_f32 v98, v98, v95
    v_rcp_f32 v96, v96
    v_rcp_f32 v98, v98
    s_nop 0
    v_pk_mul_f32 v[64:65], v[64:65], v[96:97] op_sel:[0,0] op_sel_hi:[1,0]
    v_pk_mul_f32 v[80:81], v[80:81], v[98:99] op_sel:[0,0] op_sel_hi:[1,0]
    v_pk_mul_f32 v[66:67], v[66:67], v[96:97] op_sel:[0,0] op_sel_hi:[1,0]
    v_pk_mul_f32 v[82:83], v[82:83], v[98:99] op_sel:[0,0] op_sel_hi:[1,0]
    v_pk_mul_f32 v[68:69], v[68:69], v[96:97] op_sel:[0,0] op_sel_hi:[1,0]
    v_pk_mul_f32 v[84:85], v[84:85], v[98:99] op_sel:[0,0] op_sel_hi:[1,0]
    v_pk_mul_f32 v[70:71], v[70:71], v[96:97] op_sel:[0,0] op_sel_hi:[1,0]
    v_pk_mul_f32 v[86:87], v[86:87], v[98:99] op_sel:[0,0] op_sel_hi:[1,0]
    v_pk_mul_f32 v[72:73], v[72:73], v[96:97] op_sel:[0,0] op_sel_hi:[1,0]
    v_pk_mul_f32 v[88:89], v[88:89], v[98:99] op_sel:[0,0] op_sel_hi:[1,0]
    v_cvt_pk_bf16_f32 v100, v64, v65
    v_cvt_pk_bf16_f32 v106, v80, v81
    v_cvt_pk_bf16_f32 v101, v66, v67
    v_cvt_pk_bf16_f32 v107, v82, v83
    v_cvt_pk_bf16_f32 v102, v68, v69
    v_cvt_pk_bf16_f32 v108, v84, v85
    v_cvt_pk_bf16_f32 v103, v70, v71
    v_cvt_pk_bf16_f32 v109, v86, v87
    v_cvt_pk_bf16_f32 v104, v72, v73
    v_cvt_pk_bf16_f32 v110, v88, v89
    ds_write_b64 v38, v[100:101] offset:16384
    ds_write_b64 v39, v[102:103] offset:16384
    ds_write_b32 v40, v104 offset:16384
    ds_write_b64 v38, v[106:107] offset:24576
    ds_write_b64 v39, v[108:109] offset:24576
    ds_write_b32 v40, v110 offset:24576
    v_add_u32 v41, 0, v36
    v_xor_b32 v41, v41, v35
    v_lshl_add_u32 v41, v41, 3, v34
    ds_write_b64 v41, v[24:25] offset:32768
    v_add_u32 v41, 2, v36
    v_xor_b32 v41, v41, v35
    v_lshl_add_u32 v41, v41, 3, v34
    ds_write_b64 v41, v[26:27] offset:32768
    v_mul_i32_i24 v41, -4, v36
    v_add_u32 v41, 4, v41
    v_xor_b32 v41, v41, v35
    v_lshl_add_u32 v41, v41, 3, v34
    v_mul_i32_i24 v37, 8192, v36
    v_add_u32 v41, v41, v37
    ds_write_b64 v41, v[28:29] offset:32768
    v_add_u32 v41, 1, v36
    v_xor_b32 v41, v41, v35
    v_lshl_add_u32 v41, v41, 3, v34
    v_add_u32 v41, 8192, v41
    ds_write_b64 v41, v[30:31] offset:32768
    v_add_u32 v41, 3, v36
    v_xor_b32 v41, v41, v35
    v_lshl_add_u32 v41, v41, 3, v34
    v_add_u32 v41, 8192, v41
    ds_write_b64 v41, v[32:33] offset:32768
    v_mul_i32_i24 v41, 0, v36
    v_add_u32 v41, 5, v41
    v_xor_b32 v41, v41, v35
    v_lshl_add_u32 v41, v41, 3, v34
    v_mul_i32_i24 v37, 8192, v36
    v_add_u32 v41, v41, v37
    v_mov_b32 v92, 0x3f80
    v_mov_b32 v93, 0
    ds_write_b64 v41, v[92:93] offset:32768
    s_waitcnt lgkmcnt(0)
    s_barrier
    v_bfe_u32 v92, v0, 2, 2
    v_lshrrev_b32 v93, 5, v0
    v_lshlrev_b32 v94, 3, v93
    v_add_u32 v94, v94, v92
    v_lshlrev_b32 v94, 6, v94
    v_bfe_u32 v95, v0, 4, 1
    v_lshlrev_b32 v95, 2, v95
    v_and_b32 v96, 3, v0
    v_add_u32 v95, v95, v96
    v_lshlrev_b32 v96, 2, v93
    v_lshrrev_b32 v97, 1, v92
    v_add_u32 v96, v96, v97
    v_xor_b32 v97, v95, v96
    v_lshl_add_u32 v38, v97, 3, v94
    v_add_u32 v96, 2, v96
    v_xor_b32 v97, v95, v96
    v_lshl_add_u32 v39, v97, 3, v94
    v_add_u32 v39, 256, v39
    s_and_b32 s25, s20, 1
    s_lshr_b32 s26, s20, 1
    s_lshl_b32 s27, s25, 1
    s_add_u32 s27, s27, s26
    s_lshl_b32 s27, s27, 13
    s_lshl_b32 s28, s25, 13
    s_add_u32 s28, s28, 32768
    v_add_u32 v40, s27, v38
    v_add_u32 v41, s27, v39
    v_add_u32 v42, s28, v38
    v_add_u32 v43, s28, v39
    ds_read_b64_tr_b16 v[80:81], v42 offset:0
    ds_read_b64_tr_b16 v[82:83], v43 offset:0
    ds_read_b64_tr_b16 v[84:85], v40 offset:0
    ds_read_b64_tr_b16 v[86:87], v41 offset:0
    ds_read_b64_tr_b16 v[88:89], v42 offset:1024
    ds_read_b64_tr_b16 v[90:91], v43 offset:1024
    ds_read_b64_tr_b16 v[92:93], v40 offset:1024
    ds_read_b64_tr_b16 v[94:95], v41 offset:1024
    ds_read_b64_tr_b16 v[96:97], v42 offset:2048
    ds_read_b64_tr_b16 v[98:99], v43 offset:2048
    ds_read_b64_tr_b16 v[100:101], v40 offset:2048
    ds_read_b64_tr_b16 v[102:103], v41 offset:2048
    ds_read_b64_tr_b16 v[104:105], v42 offset:3072
    ds_read_b64_tr_b16 v[106:107], v43 offset:3072
    ds_read_b64_tr_b16 v[108:109], v40 offset:3072
    ds_read_b64_tr_b16 v[110:111], v41 offset:3072
    s_waitcnt lgkmcnt(12)
    v_mfma_f32_32x32x16_bf16 v[64:79], v[84:87], v[80:83], 0
    s_waitcnt lgkmcnt(8)
    v_mfma_f32_32x32x16_bf16 v[64:79], v[92:95], v[88:91], v[64:79]
    s_waitcnt lgkmcnt(4)
    v_mfma_f32_32x32x16_bf16 v[64:79], v[100:103], v[96:99], v[64:79]
    s_waitcnt lgkmcnt(0)
    v_mfma_f32_32x32x16_bf16 v[64:79], v[108:111], v[104:107], v[64:79]
    ds_read_b64_tr_b16 v[80:81], v42 offset:4096
    ds_read_b64_tr_b16 v[82:83], v43 offset:4096
    ds_read_b64_tr_b16 v[84:85], v40 offset:4096
    ds_read_b64_tr_b16 v[86:87], v41 offset:4096
    ds_read_b64_tr_b16 v[88:89], v42 offset:5120
    ds_read_b64_tr_b16 v[90:91], v43 offset:5120
    ds_read_b64_tr_b16 v[92:93], v40 offset:5120
    ds_read_b64_tr_b16 v[94:95], v41 offset:5120
    ds_read_b64_tr_b16 v[96:97], v42 offset:6144
    ds_read_b64_tr_b16 v[98:99], v43 offset:6144
    ds_read_b64_tr_b16 v[100:101], v40 offset:6144
    ds_read_b64_tr_b16 v[102:103], v41 offset:6144
    ds_read_b64_tr_b16 v[104:105], v42 offset:7168
    ds_read_b64_tr_b16 v[106:107], v43 offset:7168
    ds_read_b64_tr_b16 v[108:109], v40 offset:7168
    ds_read_b64_tr_b16 v[110:111], v41 offset:7168
    s_waitcnt lgkmcnt(12)
    v_mfma_f32_32x32x16_bf16 v[64:79], v[84:87], v[80:83], v[64:79]
    s_waitcnt lgkmcnt(8)
    v_mfma_f32_32x32x16_bf16 v[64:79], v[92:95], v[88:91], v[64:79]
    s_waitcnt lgkmcnt(4)
    v_mfma_f32_32x32x16_bf16 v[64:79], v[100:103], v[96:99], v[64:79]
    s_waitcnt lgkmcnt(0)
    v_mfma_f32_32x32x16_bf16 v[64:79], v[108:111], v[104:107], v[64:79]
    v_and_b32 v92, 31, v0
    v_lshrrev_b32 v93, 5, v0
    v_mul_u32_u24 v94, 80, v92
    v_lshl_add_u32 v94, v93, 4, v94
    s_lshl_b32 s27, s41, 1
    s_add_u32 s27, s27, s25
    s_lshl_b32 s27, s27, 1
    s_add_u32 s27, s27, s26
    s_lshl_b32 s28, s40, 6
    s_add_u32 s27, s27, s28
    s_mul_i32 s27, s27, 1680
    s_add_u32 s27, s27, 15728640
    v_cmp_ge_u32 vcc, 20, v92
    s_nop 4
    s_and_b64 exec, exec, vcc
    buffer_store_dwordx4 v[64:67], v94, s[16:19], s27 offen sc1
    buffer_store_dwordx4 v[68:71], v94, s[16:19], s27 offen offset:32 sc1
    s_mov_b32 exec_hi, 0
    buffer_store_dwordx4 v[72:75], v94, s[16:19], s27 offen offset:64 sc1
    s_mov_b64 exec, -1
    v_mfma_f32_32x32x16_bf16 v[112:127], v[52:55], v[4:7], 0
    v_mfma_f32_32x32x8_bf16 v[112:127], v[60:61], v[8:9], v[112:127]
    s_nop 7
    s_nop 4
    v_max3_f32 v92, v112, v113, v114
    v_min3_f32 v93, v112, v113, v114
    v_max3_f32 v92, v92, v115, v116
    v_min3_f32 v93, v93, v115, v116
    v_max3_f32 v92, v92, v117, v118
    v_min3_f32 v93, v93, v117, v118
    v_max3_f32 v92, v92, v119, v120
    v_min3_f32 v93, v93, v119, v120
    v_max_f32 v92, v92, v121
    v_min_f32 v93, v93, v121
    v_mov_b32 v94, v92
    v_mov_b32 v95, v93
    s_nop 1
    v_permlane32_swap_b32 v92, v94
    v_permlane32_swap_b32 v93, v95
    s_nop 1
    v_max_f32 v92, v92, v94
    v_min_f32 v93, v93, v95
    v_mul_f32 v92, s53, v92
    v_mul_f32 v93, s52, v93
    v_pk_fma_f32 v[80:81], v[112:113], s[86:87], v[92:93] op_sel:[0,0,1] op_sel_hi:[1,1,1]
    v_pk_fma_f32 v[112:113], v[112:113], s[100:101], v[92:93] op_sel:[0,0,0] op_sel_hi:[1,1,0]
    v_pk_fma_f32 v[82:83], v[114:115], s[86:87], v[92:93] op_sel:[0,0,1] op_sel_hi:[1,1,1]
    v_pk_fma_f32 v[114:115], v[114:115], s[100:101], v[92:93] op_sel:[0,0,0] op_sel_hi:[1,1,0]
    v_pk_fma_f32 v[84:85], v[116:117], s[86:87], v[92:93] op_sel:[0,0,1] op_sel_hi:[1,1,1]
    v_pk_fma_f32 v[116:117], v[116:117], s[100:101], v[92:93] op_sel:[0,0,0] op_sel_hi:[1,1,0]
    v_pk_fma_f32 v[86:87], v[118:119], s[86:87], v[92:93] op_sel:[0,0,1] op_sel_hi:[1,1,1]
    v_pk_fma_f32 v[118:119], v[118:119], s[100:101], v[92:93] op_sel:[0,0,0] op_sel_hi:[1,1,0]
    v_pk_fma_f32 v[88:89], v[120:121], s[86:87], v[92:93] op_sel:[0,0,1] op_sel_hi:[1,1,1]
    v_pk_fma_f32 v[120:121], v[120:121], s[100:101], v[92:93] op_sel:[0,0,0] op_sel_hi:[1,1,0]
    v_exp_f32 v112, v112
    v_exp_f32 v80, v80
    v_exp_f32 v113, v113
    v_exp_f32 v81, v81
    v_exp_f32 v114, v114
    v_exp_f32 v82, v82
    v_exp_f32 v115, v115
    v_exp_f32 v83, v83
    v_exp_f32 v116, v116
    v_exp_f32 v84, v84
    v_exp_f32 v117, v117
    v_exp_f32 v85, v85
    v_exp_f32 v118, v118
    v_exp_f32 v86, v86
    v_exp_f32 v119, v119
    v_exp_f32 v87, v87
    v_exp_f32 v120, v120
    v_exp_f32 v88, v88
    v_exp_f32 v121, v121
    v_exp_f32 v89, v89
    s_nop 0
    v_pk_add_f32 v[96:97], v[112:113], v[114:115]
    v_pk_add_f32 v[98:99], v[80:81], v[82:83]
    v_pk_add_f32 v[96:97], v[96:97], v[116:117]
    v_pk_add_f32 v[98:99], v[98:99], v[84:85]
    v_pk_add_f32 v[96:97], v[96:97], v[118:119]
    v_pk_add_f32 v[98:99], v[98:99], v[86:87]
    v_pk_add_f32 v[96:97], v[96:97], v[120:121]
    v_pk_add_f32 v[98:99], v[98:99], v[88:89]
    v_add_f32 v96, v96, v97
    v_add_f32 v98, v98, v99
    v_mov_b32 v94, v96
    v_mov_b32 v95, v98
    s_nop 1
    v_permlane32_swap_b32 v96, v94
    v_permlane32_swap_b32 v98, v95
    s_nop 1
    v_add_f32 v96, v96, v94
    v_add_f32 v98, v98, v95
    v_rcp_f32 v96, v96
    v_rcp_f32 v98, v98
    s_nop 0
    v_pk_mul_f32 v[112:113], v[112:113], v[96:97] op_sel:[0,0] op_sel_hi:[1,0]
    v_pk_mul_f32 v[80:81], v[80:81], v[98:99] op_sel:[0,0] op_sel_hi:[1,0]
    v_pk_mul_f32 v[114:115], v[114:115], v[96:97] op_sel:[0,0] op_sel_hi:[1,0]
    v_pk_mul_f32 v[82:83], v[82:83], v[98:99] op_sel:[0,0] op_sel_hi:[1,0]
    v_pk_mul_f32 v[116:117], v[116:117], v[96:97] op_sel:[0,0] op_sel_hi:[1,0]
    v_pk_mul_f32 v[84:85], v[84:85], v[98:99] op_sel:[0,0] op_sel_hi:[1,0]
    v_pk_mul_f32 v[118:119], v[118:119], v[96:97] op_sel:[0,0] op_sel_hi:[1,0]
    v_pk_mul_f32 v[86:87], v[86:87], v[98:99] op_sel:[0,0] op_sel_hi:[1,0]
    v_pk_mul_f32 v[120:121], v[120:121], v[96:97] op_sel:[0,0] op_sel_hi:[1,0]
    v_pk_mul_f32 v[88:89], v[88:89], v[98:99] op_sel:[0,0] op_sel_hi:[1,0]
    v_cvt_pk_bf16_f32 v100, v112, v113
    v_cvt_pk_bf16_f32 v106, v80, v81
    v_cvt_pk_bf16_f32 v101, v114, v115
    v_cvt_pk_bf16_f32 v107, v82, v83
    v_cvt_pk_bf16_f32 v102, v116, v117
    v_cvt_pk_bf16_f32 v108, v84, v85
    v_cvt_pk_bf16_f32 v103, v118, v119
    v_cvt_pk_bf16_f32 v109, v86, v87
    v_cvt_pk_bf16_f32 v104, v120, v121
    v_cvt_pk_bf16_f32 v110, v88, v89
    v_mov_b32 v105, 0
    v_mov_b32 v111, 0
    v_mfma_f32_32x32x16_bf16 v[112:127], v[56:59], v[10:13], 0
    v_mfma_f32_32x32x8_bf16 v[112:127], v[62:63], v[8:9], v[112:127]
    s_nop 7
    s_nop 4
    v_max3_f32 v92, v112, v113, v114
    v_min3_f32 v93, v112, v113, v114
    v_max3_f32 v92, v92, v115, v116
    v_min3_f32 v93, v93, v115, v116
    v_max3_f32 v92, v92, v117, v118
    v_min3_f32 v93, v93, v117, v118
    v_max3_f32 v92, v92, v119, v120
    v_min3_f32 v93, v93, v119, v120
    v_max_f32 v92, v92, v121
    v_min_f32 v93, v93, v121
    v_mov_b32 v94, v92
    v_mov_b32 v95, v93
    s_nop 1
    v_permlane32_swap_b32 v92, v94
    v_permlane32_swap_b32 v93, v95
    s_nop 1
    v_max_f32 v92, v92, v94
    v_min_f32 v93, v93, v95
    v_mul_f32 v92, s53, v92
    v_mul_f32 v93, s52, v93
    v_pk_fma_f32 v[80:81], v[112:113], s[86:87], v[92:93] op_sel:[0,0,1] op_sel_hi:[1,1,1]
    v_pk_fma_f32 v[112:113], v[112:113], s[100:101], v[92:93] op_sel:[0,0,0] op_sel_hi:[1,1,0]
    v_pk_fma_f32 v[82:83], v[114:115], s[86:87], v[92:93] op_sel:[0,0,1] op_sel_hi:[1,1,1]
    v_pk_fma_f32 v[114:115], v[114:115], s[100:101], v[92:93] op_sel:[0,0,0] op_sel_hi:[1,1,0]
    v_pk_fma_f32 v[84:85], v[116:117], s[86:87], v[92:93] op_sel:[0,0,1] op_sel_hi:[1,1,1]
    v_pk_fma_f32 v[116:117], v[116:117], s[100:101], v[92:93] op_sel:[0,0,0] op_sel_hi:[1,1,0]
    v_pk_fma_f32 v[86:87], v[118:119], s[86:87], v[92:93] op_sel:[0,0,1] op_sel_hi:[1,1,1]
    v_pk_fma_f32 v[118:119], v[118:119], s[100:101], v[92:93] op_sel:[0,0,0] op_sel_hi:[1,1,0]
    v_pk_fma_f32 v[88:89], v[120:121], s[86:87], v[92:93] op_sel:[0,0,1] op_sel_hi:[1,1,1]
    v_pk_fma_f32 v[120:121], v[120:121], s[100:101], v[92:93] op_sel:[0,0,0] op_sel_hi:[1,1,0]
    v_exp_f32 v112, v112
    v_exp_f32 v80, v80
    v_exp_f32 v113, v113
    v_exp_f32 v81, v81
    v_exp_f32 v114, v114
    v_exp_f32 v82, v82
    v_exp_f32 v115, v115
    v_exp_f32 v83, v83
    v_exp_f32 v116, v116
    v_exp_f32 v84, v84
    v_exp_f32 v117, v117
    v_exp_f32 v85, v85
    v_exp_f32 v118, v118
    v_exp_f32 v86, v86
    v_exp_f32 v119, v119
    v_exp_f32 v87, v87
    v_exp_f32 v120, v120
    v_exp_f32 v88, v88
    v_exp_f32 v121, v121
    v_exp_f32 v89, v89
    s_nop 0
    v_pk_add_f32 v[96:97], v[112:113], v[114:115]
    v_pk_add_f32 v[98:99], v[80:81], v[82:83]
    v_pk_add_f32 v[96:97], v[96:97], v[116:117]
    v_pk_add_f32 v[98:99], v[98:99], v[84:85]
    v_pk_add_f32 v[96:97], v[96:97], v[118:119]
    v_pk_add_f32 v[98:99], v[98:99], v[86:87]
    v_pk_add_f32 v[96:97], v[96:97], v[120:121]
    v_pk_add_f32 v[98:99], v[98:99], v[88:89]
    v_add_f32 v96, v96, v97
    v_add_f32 v98, v98, v99
    v_mov_b32 v94, v96
    v_mov_b32 v95, v98
    s_nop 1
    v_permlane32_swap_b32 v96, v94
    v_permlane32_swap_b32 v98, v95
    s_nop 1
    v_add_f32 v96, v96, v94
    v_add_f32 v98, v98, v95
    v_rcp_f32 v96, v96
    v_rcp_f32 v98, v98
    s_nop 0
    v_pk_mul_f32 v[112:113], v[112:113], v[96:97] op_sel:[0,0] op_sel_hi:[1,0]
    v_pk_mul_f32 v[80:81], v[80:81], v[98:99] op_sel:[0,0] op_sel_hi:[1,0]
    v_pk_mul_f32 v[114:115], v[114:115], v[96:97] op_sel:[0,0] op_sel_hi:[1,0]
    v_pk_mul_f32 v[82:83], v[82:83], v[98:99] op_sel:[0,0] op_sel_hi:[1,0]
    v_pk_mul_f32 v[116:117], v[116:117], v[96:97] op_sel:[0,0] op_sel_hi:[1,0]
    v_pk_mul_f32 v[84:85], v[84:85], v[98:99] op_sel:[0,0] op_sel_hi:[1,0]
    v_pk_mul_f32 v[118:119], v[118:119], v[96:97] op_sel:[0,0] op_sel_hi:[1,0]
    v_pk_mul_f32 v[86:87], v[86:87], v[98:99] op_sel:[0,0] op_sel_hi:[1,0]
    v_pk_mul_f32 v[120:121], v[120:121], v[96:97] op_sel:[0,0] op_sel_hi:[1,0]
    v_pk_mul_f32 v[88:89], v[88:89], v[98:99] op_sel:[0,0] op_sel_hi:[1,0]
    v_cvt_pk_bf16_f32 v14, v112, v113
    v_cvt_pk_bf16_f32 v20, v80, v81
    v_cvt_pk_bf16_f32 v15, v114, v115
    v_cvt_pk_bf16_f32 v21, v82, v83
    v_cvt_pk_bf16_f32 v16, v116, v117
    v_cvt_pk_bf16_f32 v22, v84, v85
    v_cvt_pk_bf16_f32 v17, v118, v119
    v_cvt_pk_bf16_f32 v23, v86, v87
    v_cvt_pk_bf16_f32 v18, v120, v121
    v_cvt_pk_bf16_f32 v24, v88, v89
    v_mov_b32 v19, 0
    v_mov_b32 v25, 0
    s_waitcnt vmcnt(0)
    s_barrier
    s_cmp_lg_u32 s20, 0
    s_cbranch_scc1 L_a_wait_done_2023
    s_lshl_b32 s25, s41, 7
    s_add_u32 s25, s25, 15204352
    s_lshl_b32 s28, s40, 2
    v_mov_b32 v92, s28
    v_mov_b32 v93, s98
    s_mov_b64 exec, 1
    buffer_store_dword v93, v92, s[16:19], s25 offen sc1
    s_mov_b64 exec, 0xffff
    v_lshlrev_b32 v92, 2, v0
    s_mov_b32 s26, 0
L_a_poll_2024:
    buffer_load_dword v94, v92, s[16:19], s25 offen sc1
    s_waitcnt vmcnt(0)
    v_cmp_eq_u32 vcc, s98, v94
    s_add_u32 s26, s26, 1
    s_nop 1
    s_cmp_eq_u32 vcc_lo, 0xffff
    s_cbranch_scc1 L_a_poll_done_2025
    s_sleep 8
    s_cmp_lt_u32 s26, 0x40000
    s_cbranch_scc1 L_a_poll_2024
L_a_poll_done_2025:
    s_mov_b64 exec, -1
L_a_wait_done_2023:
    s_barrier
    s_and_b32 s25, s20, 1
    s_lshr_b32 s26, s20, 1
    s_lshl_b32 s25, s25, 1
    s_add_u32 s25, s25, s26
    s_lshl_b32 s26, s41, 2
    s_add_u32 s26, s26, s25
    s_mul_i32 s26, s26, 1680
    s_add_u32 s26, s26, 15728640
    v_lshlrev_b32 v44, 4, v0
    v_add_u32 v45, 1024, v44
    v_mov_b32 v46, 0x7000000
    v_cmp_gt_u32 vcc, 41, v0
    s_nop 1
    v_cndmask_b32 v45, v46, v45, vcc
    v_mov_b32 v26, 0
    v_mov_b32 v27, 0
    v_mov_b32 v28, 0
    v_mov_b32 v29, 0
    v_mov_b32 v30, 0
    v_mov_b32 v31, 0
    v_mov_b32 v32, 0
    v_mov_b32 v33, 0
    s_add_u32 s27, s26, 0
    buffer_load_dwordx4 v[64:67], v44, s[16:19], s27 offen sc1
    buffer_load_dwordx4 v[68:71], v45, s[16:19], s27 offen sc1
    s_add_u32 s27, s26, 107520
    buffer_load_dwordx4 v[72:75], v44, s[16:19], s27 offen sc1
    buffer_load_dwordx4 v[76:79], v45, s[16:19], s27 offen sc1
    s_add_u32 s27, s26, 215040
    buffer_load_dwordx4 v[80:83], v44, s[16:19], s27 offen sc1
    buffer_load_dwordx4 v[84:87], v45, s[16:19], s27 offen sc1
    s_add_u32 s27, s26, 322560
    buffer_load_dwordx4 v[88:91], v44, s[16:19], s27 offen sc1
    buffer_load_dwordx4 v[92:95], v45, s[16:19], s27 offen sc1
    s_add_u32 s27, s26, 430080
    buffer_load_dwordx4 v[112:115], v44, s[16:19], s27 offen sc1
    buffer_load_dwordx4 v[116:119], v45, s[16:19], s27 offen sc1
    s_add_u32 s27, s26, 537600
    buffer_load_dwordx4 v[120:123], v44, s[16:19], s27 offen sc1
    buffer_load_dwordx4 v[124:127], v45, s[16:19], s27 offen sc1
    s_waitcnt vmcnt(4)
    v_pk_add_f32 v[26:27], v[26:27], v[64:65]
    v_pk_add_f32 v[28:29], v[28:29], v[66:67]
    v_pk_add_f32 v[30:31], v[30:31], v[68:69]
    v_pk_add_f32 v[32:33], v[32:33], v[70:71]
    v_pk_add_f32 v[26:27], v[26:27], v[72:73]
    v_pk_add_f32 v[28:29], v[28:29], v[74:75]
    v_pk_add_f32 v[30:31], v[30:31], v[76:77]
    v_pk_add_f32 v[32:33], v[32:33], v[78:79]
    v_pk_add_f32 v[26:27], v[26:27], v[80:81]
    v_pk_add_f32 v[28:29], v[28:29], v[82:83]
    v_pk_add_f32 v[30:31], v[30:31], v[84:85]
    v_pk_add_f32 v[32:33], v[32:33], v[86:87]
    v_pk_add_f32 v[26:27], v[26:27], v[88:89]
    v_pk_add_f32 v[28:29], v[28:29], v[90:91]
    v_pk_add_f32 v[30:31], v[30:31], v[92:93]
    v_pk_add_f32 v[32:33], v[32:33], v[94:95]
    s_add_u32 s27, s26, 645120
    buffer_load_dwordx4 v[64:67], v44, s[16:19], s27 offen sc1
    buffer_load_dwordx4 v[68:71], v45, s[16:19], s27 offen sc1
    s_add_u32 s27, s26, 752640
    buffer_load_dwordx4 v[72:75], v44, s[16:19], s27 offen sc1
    buffer_load_dwordx4 v[76:79], v45, s[16:19], s27 offen sc1
    s_add_u32 s27, s26, 860160
    buffer_load_dwordx4 v[80:83], v44, s[16:19], s27 offen sc1
    buffer_load_dwordx4 v[84:87], v45, s[16:19], s27 offen sc1
    s_add_u32 s27, s26, 967680
    buffer_load_dwordx4 v[88:91], v44, s[16:19], s27 offen sc1
    buffer_load_dwordx4 v[92:95], v45, s[16:19], s27 offen sc1
    s_waitcnt vmcnt(8)
    v_pk_add_f32 v[26:27], v[26:27], v[112:113]
    v_pk_add_f32 v[28:29], v[28:29], v[114:115]
    v_pk_add_f32 v[30:31], v[30:31], v[116:117]
    v_pk_add_f32 v[32:33], v[32:33], v[118:119]
    v_pk_add_f32 v[26:27], v[26:27], v[120:121]
    v_pk_add_f32 v[28:29], v[28:29], v[122:123]
    v_pk_add_f32 v[30:31], v[30:31], v[124:125]
    v_pk_add_f32 v[32:33], v[32:33], v[126:127]
    s_add_u32 s27, s26, 1075200
    buffer_load_dwordx4 v[112:115], v44, s[16:19], s27 offen sc1
    buffer_load_dwordx4 v[116:119], v45, s[16:19], s27 offen sc1
    s_add_u32 s27, s26, 1182720
    buffer_load_dwordx4 v[120:123], v44, s[16:19], s27 offen sc1
    buffer_load_dwordx4 v[124:127], v45, s[16:19], s27 offen sc1
    s_waitcnt vmcnt(4)
    v_pk_add_f32 v[26:27], v[26:27], v[64:65]
    v_pk_add_f32 v[28:29], v[28:29], v[66:67]
    v_pk_add_f32 v[30:31], v[30:31], v[68:69]
    v_pk_add_f32 v[32:33], v[32:33], v[70:71]
    v_pk_add_f32 v[26:27], v[26:27], v[72:73]
    v_pk_add_f32 v[28:29], v[28:29], v[74:75]
    v_pk_add_f32 v[30:31], v[30:31], v[76:77]
    v_pk_add_f32 v[32:33], v[32:33], v[78:79]
    v_pk_add_f32 v[26:27], v[26:27], v[80:81]
    v_pk_add_f32 v[28:29], v[28:29], v[82:83]
    v_pk_add_f32 v[30:31], v[30:31], v[84:85]
    v_pk_add_f32 v[32:33], v[32:33], v[86:87]
    v_pk_add_f32 v[26:27], v[26:27], v[88:89]
    v_pk_add_f32 v[28:29], v[28:29], v[90:91]
    v_pk_add_f32 v[30:31], v[30:31], v[92:93]
    v_pk_add_f32 v[32:33], v[32:33], v[94:95]
    s_add_u32 s27, s26, 1290240
    buffer_load_dwordx4 v[64:67], v44, s[16:19], s27 offen sc1
    buffer_load_dwordx4 v[68:71], v45, s[16:19], s27 offen sc1
    s_add_u32 s27, s26, 1397760
    buffer_load_dwordx4 v[72:75], v44, s[16:19], s27 offen sc1
    buffer_load_dwordx4 v[76:79], v45, s[16:19], s27 offen sc1
    s_add_u32 s27, s26, 1505280
    buffer_load_dwordx4 v[80:83], v44, s[16:19], s27 offen sc1
    buffer_load_dwordx4 v[84:87], v45, s[16:19], s27 offen sc1
    s_add_u32 s27, s26, 1612800
    buffer_load_dwordx4 v[88:91], v44, s[16:19], s27 offen sc1
    buffer_load_dwordx4 v[92:95], v45, s[16:19], s27 offen sc1
    s_waitcnt vmcnt(8)
    v_pk_add_f32 v[26:27], v[26:27], v[112:113]
    v_pk_add_f32 v[28:29], v[28:29], v[114:115]
    v_pk_add_f32 v[30:31], v[30:31], v[116:117]
    v_pk_add_f32 v[32:33], v[32:33], v[118:119]
    v_pk_add_f32 v[26:27], v[26:27], v[120:121]
    v_pk_add_f32 v[28:29], v[28:29], v[122:123]
    v_pk_add_f32 v[30:31], v[30:31], v[124:125]
    v_pk_add_f32 v[32:33], v[32:33], v[126:127]
    s_waitcnt vmcnt(0)
    v_pk_add_f32 v[26:27], v[26:27], v[64:65]
    v_pk_add_f32 v[28:29], v[28:29], v[66:67]
    v_pk_add_f32 v[30:31], v[30:31], v[68:69]
    v_pk_add_f32 v[32:33], v[32:33], v[70:71]
    v_pk_add_f32 v[26:27], v[26:27], v[72:73]
    v_pk_add_f32 v[28:29], v[28:29], v[74:75]
    v_pk_add_f32 v[30:31], v[30:31], v[76:77]
    v_pk_add_f32 v[32:33], v[32:33], v[78:79]
    v_pk_add_f32 v[26:27], v[26:27], v[80:81]
    v_pk_add_f32 v[28:29], v[28:29], v[82:83]
    v_pk_add_f32 v[30:31], v[30:31], v[84:85]
    v_pk_add_f32 v[32:33], v[32:33], v[86:87]
    v_pk_add_f32 v[26:27], v[26:27], v[88:89]
    v_pk_add_f32 v[28:29], v[28:29], v[90:91]
    v_pk_add_f32 v[30:31], v[30:31], v[92:93]
    v_pk_add_f32 v[32:33], v[32:33], v[94:95]
    s_lshl_b32 s25, s25, 11
    v_add_u32 v46, s25, v44
    ds_write_b128 v46, v[26:29]
    s_mov_b64 s[26:27], exec
    v_cmp_gt_u32 vcc, 41, v0
    s_nop 1
    s_and_b64 exec, exec, vcc
    ds_write_b128 v46, v[30:33] offset:1024
    s_mov_b64 exec, -1
    s_waitcnt lgkmcnt(0)
    s_barrier
    v_and_b32 v92, 31, v0
    v_lshrrev_b32 v93, 5, v0
    v_mov_b32 v94, 20
    v_cmp_eq_u32 vcc, 24, v92
    s_nop 1
    v_cndmask_b32 v92, v92, v94, vcc
    v_min_u32 v95, 20, v92
    v_mul_u32_u24 v94, 80, v95
    v_lshl_add_u32 v44, v93, 4, v94
    v_lshl_add_u32 v45, v93, 3, v94
    v_cmp_lt_u32 vcc, 20, v92
    ds_read_b128 v[64:67], v44 offset:0
    ds_read_b128 v[68:71], v44 offset:32
    ds_read_b64 v[72:73], v45 offset:64
    ds_read_b128 v[74:77], v44 offset:2048
    ds_read_b128 v[78:81], v44 offset:2080
    ds_read_b64 v[82:83], v45 offset:2112
    ds_read_b128 v[84:87], v44 offset:4096
    ds_read_b128 v[88:91], v44 offset:4128
    ds_read_b64 v[92:93], v45 offset:4160
    ds_read_b128 v[116:119], v44 offset:6144
    ds_read_b128 v[120:123], v44 offset:6176
    ds_read_b64 v[124:125], v45 offset:6208
    s_waitcnt lgkmcnt(9)
    v_cvt_pk_bf16_f32 v26, v64, v65
    v_cvt_pk_bf16_f32 v27, v66, v67
    v_cvt_pk_bf16_f32 v28, v68, v69
    v_cvt_pk_bf16_f32 v29, v70, v71
    v_cvt_pk_bf16_f32 v30, v72, v73
    v_mov_b32 v31, 0
    s_waitcnt lgkmcnt(6)
    v_cvt_pk_bf16_f32 v32, v74, v75
    v_cvt_pk_bf16_f32 v33, v76, v77
    v_cvt_pk_bf16_f32 v34, v78, v79
    v_cvt_pk_bf16_f32 v35, v80, v81
    v_cvt_pk_bf16_f32 v36, v82, v83
    v_mov_b32 v37, 0
    s_waitcnt lgkmcnt(3)
    v_cvt_pk_bf16_f32 v38, v84, v85
    v_cvt_pk_bf16_f32 v39, v86, v87
    v_cvt_pk_bf16_f32 v40, v88, v89
    v_cvt_pk_bf16_f32 v41, v90, v91
    v_cvt_pk_bf16_f32 v42, v92, v93
    v_mov_b32 v43, 0
    s_waitcnt lgkmcnt(0)
    v_cvt_pk_bf16_f32 v94, v116, v117
    v_cvt_pk_bf16_f32 v95, v118, v119
    v_cvt_pk_bf16_f32 v96, v120, v121
    v_cvt_pk_bf16_f32 v97, v122, v123
    v_cvt_pk_bf16_f32 v98, v124, v125
    v_mov_b32 v99, 0
    s_nop 1
    s_nop 1
    v_mfma_f32_32x32x16_bf16 v[64:79], v[26:29], v[100:103], 0
    v_mfma_f32_32x32x8_bf16 v[64:79], v[30:31], v[104:105], v[64:79]
    v_mfma_f32_32x32x16_bf16 v[64:79], v[32:35], v[106:109], v[64:79]
    v_mfma_f32_32x32x8_bf16 v[64:79], v[36:37], v[110:111], v[64:79]
    v_mfma_f32_32x32x16_bf16 v[112:127], v[38:41], v[14:17], 0
    v_mfma_f32_32x32x8_bf16 v[112:127], v[42:43], v[18:19], v[112:127]
    v_mfma_f32_32x32x16_bf16 v[112:127], v[94:97], v[20:23], v[112:127]
    v_mfma_f32_32x32x8_bf16 v[112:127], v[98:99], v[24:25], v[112:127]
    v_and_b32 v100, 31, v0
    v_lshrrev_b32 v101, 5, v0
    v_cmp_eq_u32 vcc, 0, v101
    s_mul_i32 s25, s20, 3072
    s_add_u32 s25, s25, 16384
    v_mul_u32_u24 v100, 48, v100
    v_lshl_add_u32 v100, v101, 3, v100
    v_add_u32 v100, s25, v100
    v_lshlrev_b32 v102, 4, v0
    v_add_u32 v110, s25, v102
    s_lshl_b32 s26, s40, 5
    s_lshl_b32 s27, s41, 1
    s_add_u32 s26, s26, s27
    s_mul_i32 s26, s26, 6144
    s_mul_i32 s27, s20, 1536
    s_add_u32 s27, s27, s26
    s_add_u32 s27, s27, 20971520
    s_mov_b32 s28, 0x358637bd
    s_nop 7
    s_nop 7
    v_cndmask_b32 v103, v72, v76, vcc
    v_add_f32 v103, s28, v103
    v_rcp_f32 v103, v103
    s_nop 0
    v_pk_mul_f32 v[64:65], v[64:65], v[102:103] op_sel:[0,1] op_sel_hi:[1,1]
    v_pk_mul_f32 v[66:67], v[66:67], v[102:103] op_sel:[0,1] op_sel_hi:[1,1]
    v_pk_mul_f32 v[68:69], v[68:69], v[102:103] op_sel:[0,1] op_sel_hi:[1,1]
    v_pk_mul_f32 v[70:71], v[70:71], v[102:103] op_sel:[0,1] op_sel_hi:[1,1]
    v_pk_mul_f32 v[72:73], v[72:73], v[102:103] op_sel:[0,1] op_sel_hi:[1,1]
    v_pk_mul_f32 v[74:75], v[74:75], v[102:103] op_sel:[0,1] op_sel_hi:[1,1]
    v_cvt_pk_bf16_f32 v104, v64, v65
    v_cvt_pk_bf16_f32 v105, v66, v67
    v_cvt_pk_bf16_f32 v106, v68, v69
    v_cvt_pk_bf16_f32 v107, v70, v71
    v_cvt_pk_bf16_f32 v108, v72, v73
    v_cvt_pk_bf16_f32 v109, v74, v75
    v_cndmask_b32 v108, 0, v108, vcc
    v_cndmask_b32 v109, 0, v109, vcc
    ds_write_b64 v100, v[104:105] offset:0
    ds_write_b64 v100, v[106:107] offset:16
    ds_write_b64 v100, v[108:109] offset:32
    v_cndmask_b32 v103, v120, v124, vcc
    v_add_f32 v103, s28, v103
    v_rcp_f32 v103, v103
    s_nop 0
    v_pk_mul_f32 v[112:113], v[112:113], v[102:103] op_sel:[0,1] op_sel_hi:[1,1]
    v_pk_mul_f32 v[114:115], v[114:115], v[102:103] op_sel:[0,1] op_sel_hi:[1,1]
    v_pk_mul_f32 v[116:117], v[116:117], v[102:103] op_sel:[0,1] op_sel_hi:[1,1]
    v_pk_mul_f32 v[118:119], v[118:119], v[102:103] op_sel:[0,1] op_sel_hi:[1,1]
    v_pk_mul_f32 v[120:121], v[120:121], v[102:103] op_sel:[0,1] op_sel_hi:[1,1]
    v_pk_mul_f32 v[122:123], v[122:123], v[102:103] op_sel:[0,1] op_sel_hi:[1,1]
    v_cvt_pk_bf16_f32 v104, v112, v113
    v_cvt_pk_bf16_f32 v105, v114, v115
    v_cvt_pk_bf16_f32 v106, v116, v117
    v_cvt_pk_bf16_f32 v107, v118, v119
    v_cvt_pk_bf16_f32 v108, v120, v121
    v_cvt_pk_bf16_f32 v109, v122, v123
    v_cndmask_b32 v108, 0, v108, vcc
    v_cndmask_b32 v109, 0, v109, vcc
    ds_write_b64 v100, v[104:105] offset:1536
    ds_write_b64 v100, v[106:107] offset:1552
    ds_write_b64 v100, v[108:109] offset:1568
    s_waitcnt lgkmcnt(0)
    ds_read_b128 v[4:7], v110
    ds_read_b128 v[8:11], v110 offset:1536
    ds_read_b128 v[16:19], v110 offset:1024
    ds_read_b128 v[20:23], v110 offset:2560
    s_waitcnt lgkmcnt(0)
    buffer_store_dwordx4 v[4:7], v102, s[16:19], s27 offen sc1
    s_add_u32 s28, s27, 6144
    buffer_store_dwordx4 v[8:11], v102, s[16:19], s28 offen sc1
    s_mov_b32 exec_hi, 0
    buffer_store_dwordx4 v[16:19], v102, s[16:19], s27 offen offset:1024 sc1
    buffer_store_dwordx4 v[20:23], v102, s[16:19], s28 offen offset:1024 sc1
    s_mov_b64 exec, -1
    s_waitcnt vmcnt(0)
    s_barrier
    s_cmp_lg_u32 s20, 0
    s_cbranch_scc1 L_a_noflag_2026
    s_lshl_b32 s25, s40, 7
    s_add_u32 s25, s25, 15208448
    s_lshl_b32 s26, s41, 2
    v_mov_b32 v100, s26
    v_mov_b32 v101, s98
    s_mov_b64 exec, 1
    buffer_store_dword v101, v100, s[16:19], s25 offen sc1
    s_mov_b64 exec, -1
L_a_noflag_2026:
    s_bitcmp0_b32 s2, 3
    s_cbranch_scc1 L_a_exit_2027
    s_setprio 0
    s_mov_b32 s42, 0
    s_branch L_out_compute_shared
L_a_exit_2027:
    s_endpgm
L_done_2001:
    s_endpgm
L_k2_code_end:
.section .rodata,"a"
.p2align 6
.amdhsa_kernel qkv_kernel
  .amdhsa_next_free_vgpr 128
  .amdhsa_next_free_sgpr 102
  .amdhsa_accum_offset 128
  .amdhsa_group_segment_fixed_size 0
  .amdhsa_kernarg_size 80
  .amdhsa_user_sgpr_count 2
  .amdhsa_user_sgpr_kernarg_segment_ptr 1
  .amdhsa_system_sgpr_workgroup_id_x 1
.end_amdhsa_kernel
.p2align 6
.amdhsa_kernel attn_kernel
  .amdhsa_next_free_vgpr 128
  .amdhsa_next_free_sgpr 102
  .amdhsa_accum_offset 128
  .amdhsa_group_segment_fixed_size 0
  .amdhsa_kernarg_size 80
  .amdhsa_user_sgpr_count 2
  .amdhsa_user_sgpr_kernarg_segment_ptr 1
  .amdhsa_system_sgpr_workgroup_id_x 1
.end_amdhsa_kernel
```
